```python
import torch

def _softmax(x, axis=-1):
    return torch.softmax(x, dim=axis)
def _gelu(x):
    return torch.nn.functional.gelu(x, approximate="tanh")
def _silu(x):
    return torch.nn.functional.silu(x)
def _sigmoid(x):
    return torch.sigmoid(x)
def _layernorm(x, axis=-1, eps=1e-5):
    m = x.mean(dim=axis, keepdim=True)
    v = x.var(dim=axis, keepdim=True, unbiased=False)
    return (x - m) / torch.sqrt(v + eps)
def _scatter_add(tgt, idx, src, axis=0):
    return tgt.clone().index_add_(axis, idx, src)
def _segment_sum(src, seg, n):
    out = torch.zeros((n,) + src.shape[1:], dtype=src.dtype)
    return out.index_add_(0, seg, src)
def _pad(x, pw):
    flat = tuple(v for pair in reversed(pw) for v in pair)
    return torch.nn.functional.pad(x, flat)

kernel_name = 'standalone__deep_cross_xdeepfm__recsys'

def setup_inputs():

    _w = (lambda a: (lambda t: t.to(torch.bfloat16) if t.is_floating_point() else t)(torch.as_tensor(a)))
    B, F, D, L = 16384, 26, 16, 3
    V = min(1000, 100000)
    Din = F * D
    return {
        "idx": _w((lambda lo, hi, *s: torch.randint(lo, hi, s))(0, V, B, F).to(torch.int64)),
        "table": _w((lambda *s: torch.randn(*s, dtype=torch.bfloat16) * 0.8)(V, D)),
        "ws_cin": _w((lambda *s: torch.randn(*s, dtype=torch.bfloat16) * 0.2)(L, F, F, F) * (1.0 / F)),
        "w_cin_out": _w((lambda *s: torch.randn(*s, dtype=torch.bfloat16) * 0.2)(L * F) * ((L * F) ** -0.5)),
        "w_dnn1": _w((lambda *s: torch.randn(*s, dtype=torch.bfloat16) * 0.8)(Din, Din) * (Din ** -0.5)),
        "b_dnn1": _w((lambda *s: torch.randn(*s, dtype=torch.bfloat16) * 3.2)(Din) * 0.1),
        "w_dnn2": _w((lambda *s: torch.randn(*s, dtype=torch.bfloat16) * 0.2)(Din) * (Din ** -0.5)),
        "b_out": _w((lambda *s: torch.randn(*s, dtype=torch.bfloat16) * 0.2)(1)),
    }

def reference(idx, table, ws_cin, w_cin_out, w_dnn1, b_dnn1, w_dnn2, b_out):
    x0 = table[idx]
    B = x0.shape[0]
    L = ws_cin.shape[0]
    xk = x0
    pooled = []
    for l in range(L):
        xk = torch.einsum('bid,bjd,hij->bhd', xk, x0, ws_cin[l])
        pooled.append(xk.sum(axis=-1))
    p_plus = torch.stack(pooled, axis=1).reshape(B, -1)
    logit_cin = p_plus @ w_cin_out
    h = x0.reshape(B, -1)
    h = _gelu(h @ w_dnn1 + b_dnn1)
    logit_dnn = h @ w_dnn2
    return logit_cin + logit_dnn + b_out
```

```asm
; @launch grid=(256,1,1) block=(512,1,1) lds=152704
.amdgcn_target "amdgcn-amd-amdhsa--gfx950"
.text
.globl standalone__deep_cross_xdeepfm__recsys_kernel
.p2align 8
.type standalone__deep_cross_xdeepfm__recsys_kernel,@function
standalone__deep_cross_xdeepfm__recsys_kernel:
  s_load_dwordx16 s[16:31], s[0:1], 0
  v_lshrrev_b32 v2, 6, v0
  v_and_b32 v1, 63, v0
  s_cmp_ge_u32 s2, 256
  v_readfirstlane_b32 s3, v2
  s_cbranch_scc1 L_end
  s_getpc_b64 s[94:95]
L_pc:
  s_lshr_b32 s15, s2, 3
  s_and_b32 s5, s2, 7
  s_sub_u32 s5, s5, 2
  s_cmp_lt_u32 s5, 1
  s_cselect_b32 s38, s15, 99
  s_cmp_ge_u32 s3, 4
  s_cbranch_scc1 L_D1
L_C:
  s_load_dwordx4 s[32:35], s[0:1], 64
  s_load_dwordx2 s[36:37], s[0:1], 80
  s_mov_b32 s50, 1703936
  s_mov_b32 s51, 0x20000
  v_lshlrev_b32 v32, 4, v1
  s_and_b32 s7, s3, 1
  s_lshl_b32 s12, s2, 2
  s_add_u32 s12, s12, s3
  s_mul_i32 s12, s12, 1664
  s_mul_i32 s13, s3, 1664
  s_add_u32 s13, s13, 32768
  s_mov_b32 s42, 105456
  s_mov_b32 s43, 0x20000
  s_lshl_b32 s14, s15, 2
  s_add_u32 s14, s14, s3
  s_mul_i32 s14, s14, 384
  s_add_u32 s14, s14, 70272
  v_lshlrev_b32 v7, 7, v1
  s_mov_b32 s62, 256
  s_mov_b32 s63, 0x20000
  s_waitcnt lgkmcnt(0)
  s_mov_b64 s[60:61], s[34:35]
  s_mov_b64 s[48:49], s[16:17]
  buffer_load_dwordx4 v[12:15], v32, s[48:51], s12 offen
  buffer_load_dwordx4 v[16:19], v32, s[48:51], s12 offen offset:640
  s_mov_b64 s[40:41], s[20:21]
  s_mov_b64 exec, 7
  buffer_load_dword v23, v7, s[40:43], s14 offen
  s_mov_b64 exec, -1
  s_cmp_ge_u32 s38, 14
  s_cbranch_scc1 L_CN
L_CP:
  s_cmp_ge_u32 s15, 7
  s_cbranch_scc1 L_P1x
L_P1u:
  s_setprio 3
  s_lshl_b32 s39, s15, 2
  s_add_u32 s39, s39, s3
  s_mul_i32 s93, s39, 52
  s_add_u32 s93, s93, 35152
  v_and_b32 v29, 31, v1
  v_lshrrev_b32 v30, 5, v1
  v_mul_u32_u24 v31, 1352, v29
  v_lshl_add_u32 v31, v30, 4, v31
  buffer_load_dwordx4 v[140:143], v31, s[40:43], s93 offen
  buffer_load_dwordx4 v[144:147], v31, s[40:43], s93 offen offset:32
  s_add_u32 s94, s94, L_lut-L_pc
  s_addc_u32 s95, s95, 0
  global_load_dwordx4 v[148:151], v32, s[94:95]
  global_load_dwordx4 v[152:155], v32, s[94:95] offset:1024
  global_load_dwordx4 v[156:159], v32, s[94:95] offset:2048
  s_mov_b32 s50, 156
  s_mov_b64 s[48:49], s[22:23]
  v_and_b32 v35, 48, v1
  v_lshlrev_b32 v34, 1, v29
  buffer_load_dwordx4 v[44:47], v35, s[48:51], 0 offen offset:104
  buffer_load_ushort v34, v34, s[48:51], 0 offen offset:52
  s_lshl_b32 s5, s39, 1
  v_mov_b32 v35, 0
  buffer_load_ushort v35, v35, s[48:51], s5 offen
  s_mul_i32 s90, s3, 11264
  s_add_u32 s90, s90, 39936
  s_mul_i32 s91, s3, 352
  s_add_u32 s91, s91, 70304
  v_mul_u32_u24 v20, 2979, v1
  s_add_u32 m0, s90, 0
  v_lshrrev_b32 v20, 16, v20
  v_mul_u32_u24 v20, 1000, v20
  v_lshl_add_u32 v112, v1, 4, v20
  buffer_load_dwordx4 v112, s[40:43], s91 offen lds
  v_add_u32 v22, 64, v1
  v_mul_u32_u24 v20, 2979, v22
  s_add_u32 m0, s90, 1024
  v_lshrrev_b32 v20, 16, v20
  v_mul_u32_u24 v20, 1000, v20
  v_lshl_add_u32 v113, v22, 4, v20
  buffer_load_dwordx4 v113, s[40:43], s91 offen lds
  v_add_u32 v22, 128, v1
  v_mul_u32_u24 v20, 2979, v22
  s_add_u32 m0, s90, 2048
  v_lshrrev_b32 v20, 16, v20
  v_mul_u32_u24 v20, 1000, v20
  v_lshl_add_u32 v114, v22, 4, v20
  buffer_load_dwordx4 v114, s[40:43], s91 offen lds
  v_add_u32 v22, 192, v1
  v_mul_u32_u24 v20, 2979, v22
  s_add_u32 m0, s90, 3072
  v_lshrrev_b32 v20, 16, v20
  v_mul_u32_u24 v20, 1000, v20
  v_lshl_add_u32 v115, v22, 4, v20
  buffer_load_dwordx4 v115, s[40:43], s91 offen lds
  s_branch L_P2u
L_P1x:
  s_setprio 3
  s_sub_u32 s39, s15, 7
  s_lshl_b32 s39, s39, 2
  s_add_u32 s39, s39, s3
  s_mul_i32 s93, s39, 1352
  v_and_b32 v29, 31, v1
  v_lshrrev_b32 v30, 5, v1
  v_mul_u32_u24 v31, 52, v29
  v_lshl_add_u32 v31, v30, 4, v31
  buffer_load_dwordx4 v[140:143], v31, s[40:43], s93 offen
  buffer_load_dwordx4 v[144:147], v31, s[40:43], s93 offen offset:32
  s_add_u32 s94, s94, L_lut-L_pc
  s_addc_u32 s95, s95, 0
  global_load_dwordx4 v[148:151], v32, s[94:95]
  global_load_dwordx4 v[152:155], v32, s[94:95] offset:1024
  global_load_dwordx4 v[156:159], v32, s[94:95] offset:2048
  s_barrier
  s_branch L_P2x
L_D1:
  s_sub_u32 s6, s3, 4
  s_and_b32 s5, s15, 7
  s_lshl_b32 s5, s5, 2
  s_add_u32 s5, s5, s6
  s_mul_i32 s5, s5, 1152
  v_lshl_add_u32 v8, v1, 7, s5
  v_min_u32 v8, L_lut_end-L_pc-4, v8
  s_mov_b64 exec, 0x1ff
  global_load_dword v255, v8, s[94:95]
  s_mov_b64 exec, -1
  s_mov_b32 s42, 350208
  s_mov_b32 s43, 0x20000
  s_mov_b32 s46, 32000
  s_mov_b32 s47, 0x20000
  v_bfe_u32 v33, v1, 4, 1
  v_xor_b32 v33, v33, v1
  v_lshlrev_b32 v33, 4, v33
  s_lshl_b32 s13, s6, 13
  s_add_u32 s5, s15, 0
  s_and_b32 s5, s5, 3
  s_lshl_b32 s5, s5, 11
  s_add_u32 s8, s5, s13
  s_add_u32 s5, s15, 1
  s_and_b32 s5, s5, 3
  s_lshl_b32 s5, s5, 11
  s_add_u32 s9, s5, s13
  s_add_u32 s5, s15, 2
  s_and_b32 s5, s5, 3
  s_lshl_b32 s5, s5, 11
  s_add_u32 s10, s5, s13
  s_add_u32 s5, s15, 3
  s_and_b32 s5, s5, 3
  s_lshl_b32 s5, s5, 11
  s_add_u32 s11, s5, s13
  s_add_u32 s4, s15, 18
  s_bfe_u32 s4, s4, 0x40001
  s_sub_u32 s5, s4, 13
  s_min_u32 s4, s4, s5
  s_and_b32 s39, s15, 1
  s_lshl_b32 s39, s39, 4
  s_mul_i32 s12, s4, 26624
  s_mul_i32 s7, s6, 14336
  s_add_u32 s7, s7, 84992
  s_and_b32 s14, s6, 1
  s_lshr_b32 s5, s6, 1
  s_mul_i32 s5, s5, 416
  s_mul_i32 s13, s14, 192
  s_add_u32 s13, s13, s5
  s_lshl_b32 s5, s14, 1
  v_lshl_add_u32 v10, s14, 3, v1
  v_subrev_u32 v11, 56, v10
  v_min_u32 v10, v10, v11
  v_min_u32 v10, 55, v10
  v_lshl_add_u32 v9, v10, 2, s13
  v_mul_u32_u24 v11, 4682, v1
  v_lshrrev_b32 v11, 16, v11
  v_mad_i32_i24 v12, v11, -14, v1
  v_add_u32 v12, s5, v12
  v_subrev_u32 v13, 14, v12
  v_min_u32 v12, v12, v13
  v_lshrrev_b32 v13, 1, v11
  v_xor_b32 v13, v13, v11
  v_and_b32 v13, 4, v13
  v_mul_u32_u24 v13, 3, v13
  v_bitop3_b32 v11, v11, v13, s39 bitop3:0x96
  v_mul_u32_u24 v11, 832, v11
  v_lshl_add_u32 v11, v12, 4, v11
  v_add_u32 v2, s13, v11
  v_add_u32 v2, 4096, v2
  v_add_u32 v10, 64, v1
  v_mul_u32_u24 v11, 4682, v10
  v_lshrrev_b32 v11, 16, v11
  v_mad_i32_i24 v12, v11, -14, v10
  v_add_u32 v12, s5, v12
  v_subrev_u32 v13, 14, v12
  v_min_u32 v12, v12, v13
  v_lshrrev_b32 v13, 1, v11
  v_xor_b32 v13, v13, v11
  v_and_b32 v13, 4, v13
  v_mul_u32_u24 v13, 3, v13
  v_bitop3_b32 v11, v11, v13, s39 bitop3:0x96
  v_mul_u32_u24 v11, 832, v11
  v_lshl_add_u32 v11, v12, 4, v11
  v_add_u32 v3, s13, v11
  v_add_u32 v3, 3072, v3
  v_add_u32 v10, 128, v1
  v_mul_u32_u24 v11, 4682, v10
  v_lshrrev_b32 v11, 16, v11
  v_mad_i32_i24 v12, v11, -14, v10
  v_add_u32 v12, s5, v12
  v_subrev_u32 v13, 14, v12
  v_min_u32 v12, v12, v13
  v_lshrrev_b32 v13, 1, v11
  v_xor_b32 v13, v13, v11
  v_and_b32 v13, 4, v13
  v_mul_u32_u24 v13, 3, v13
  v_bitop3_b32 v11, v11, v13, s39 bitop3:0x96
  v_mul_u32_u24 v11, 832, v11
  v_lshl_add_u32 v11, v12, 4, v11
  v_add_u32 v4, s13, v11
  v_add_u32 v4, 2048, v4
  v_add_u32 v10, 192, v1
  v_mul_u32_u24 v11, 4682, v10
  v_lshrrev_b32 v11, 16, v11
  v_mad_i32_i24 v12, v11, -14, v10
  v_add_u32 v12, s5, v12
  v_subrev_u32 v13, 14, v12
  v_min_u32 v12, v12, v13
  v_lshrrev_b32 v13, 1, v11
  v_xor_b32 v13, v13, v11
  v_and_b32 v13, 4, v13
  v_mul_u32_u24 v13, 3, v13
  v_bitop3_b32 v11, v11, v13, s39 bitop3:0x96
  v_mul_u32_u24 v11, 832, v11
  v_lshl_add_u32 v11, v12, 4, v11
  v_add_u32 v5, s13, v11
  v_add_u32 v5, 1024, v5
  s_waitcnt lgkmcnt(0)
  s_mov_b64 s[44:45], s[18:19]
  global_load_dword v14, v9, s[26:27]
  s_sub_u32 s40, s24, 4096
  s_subb_u32 s41, s25, 0
  s_mov_b32 m0, s8
  s_nop 0
  buffer_load_dwordx4 v33, s[44:47], s8 offen lds
  buffer_load_dwordx4 v33, s[44:47], s8 offen offset:1024 lds
  s_cmp_ge_u32 s38, 14
  s_cbranch_scc1 L_D_nb0
  s_barrier
L_D_nb0:
  s_add_u32 m0, s7, 0
  s_nop 0
  buffer_load_dwordx4 v2, s[40:43], s12 offen lds
  buffer_load_dwordx4 v3, s[40:43], s12 offen offset:1024 lds
  buffer_load_dwordx4 v4, s[40:43], s12 offen offset:2048 lds
  buffer_load_dwordx4 v5, s[40:43], s12 offen offset:3072 lds
  v_add_u32 v10, 256, v1
  v_mul_u32_u24 v11, 4682, v10
  v_lshrrev_b32 v11, 16, v11
  v_mad_i32_i24 v12, v11, -14, v10
  v_add_u32 v12, s5, v12
  v_subrev_u32 v13, 14, v12
  v_min_u32 v12, v12, v13
  v_lshrrev_b32 v13, 1, v11
  v_xor_b32 v13, v13, v11
  v_and_b32 v13, 4, v13
  v_mul_u32_u24 v13, 3, v13
  v_bitop3_b32 v11, v11, v13, s39 bitop3:0x96
  v_mul_u32_u24 v11, 832, v11
  v_lshl_add_u32 v11, v12, 4, v11
  v_add_u32 v6, s13, v11
  v_add_u32 v6, 4096, v6
  v_add_u32 v10, 320, v1
  v_mul_u32_u24 v11, 4682, v10
  v_lshrrev_b32 v11, 16, v11
  v_mad_i32_i24 v12, v11, -14, v10
  v_add_u32 v12, s5, v12
  v_subrev_u32 v13, 14, v12
  v_min_u32 v12, v12, v13
  v_lshrrev_b32 v13, 1, v11
  v_xor_b32 v13, v13, v11
  v_and_b32 v13, 4, v13
  v_mul_u32_u24 v13, 3, v13
  v_bitop3_b32 v11, v11, v13, s39 bitop3:0x96
  v_mul_u32_u24 v11, 832, v11
  v_lshl_add_u32 v11, v12, 4, v11
  v_add_u32 v7, s13, v11
  v_add_u32 v7, 3072, v7
  v_add_u32 v10, 384, v1
  v_mul_u32_u24 v11, 4682, v10
  v_lshrrev_b32 v11, 16, v11
  v_mad_i32_i24 v12, v11, -14, v10
  v_add_u32 v12, s5, v12
  v_subrev_u32 v13, 14, v12
  v_min_u32 v12, v12, v13
  v_lshrrev_b32 v13, 1, v11
  v_xor_b32 v13, v13, v11
  v_and_b32 v13, 4, v13
  v_mul_u32_u24 v13, 3, v13
  v_bitop3_b32 v11, v11, v13, s39 bitop3:0x96
  v_mul_u32_u24 v11, 832, v11
  v_lshl_add_u32 v11, v12, 4, v11
  v_add_u32 v8, s13, v11
  v_add_u32 v8, 2048, v8
  s_mov_b32 m0, s9
  s_nop 0
  buffer_load_dwordx4 v33, s[44:47], s9 offen lds
  buffer_load_dwordx4 v33, s[44:47], s9 offen offset:1024 lds
  s_mov_b32 m0, s10
  s_nop 0
  buffer_load_dwordx4 v33, s[44:47], s10 offen lds
  buffer_load_dwordx4 v33, s[44:47], s10 offen offset:1024 lds
  s_mov_b32 m0, s11
  s_nop 0
  buffer_load_dwordx4 v33, s[44:47], s11 offen lds
  buffer_load_dwordx4 v33, s[44:47], s11 offen offset:1024 lds
  s_add_u32 m0, s7, 4096
  s_nop 0
  buffer_load_dwordx4 v6, s[40:43], s12 offen lds
  buffer_load_dwordx4 v7, s[40:43], s12 offen offset:1024 lds
  buffer_load_dwordx4 v8, s[40:43], s12 offen offset:2048 lds
  s_add_u32 s12, s12, 26624
  s_cmp_eq_u32 s12, 346112
  s_cselect_b32 s12, 0, s12
  s_branch L_D2
L_CN:
  s_mov_b32 s54, 42336
  s_mov_b32 s55, 0x20000
  s_mov_b32 s58, 32768
  s_mov_b32 s59, 0x20000
  s_mov_b64 s[52:53], s[36:37]
  s_mov_b64 s[56:57], s[32:33]
  v_mov_b32 v2, 142336
  v_mov_b32 v24, 0
  v_mov_b32 v25, 0
  v_mov_b32 v26, 0
  v_mov_b32 v27, 0
  ds_write_b128 v2, v[24:27]
  ds_write_b32 v2, v24 offset:16
  v_mov_b32 v5, 0
  v_mov_b32 v6, 1
  v_mov_b32 v11, 65536
  s_mov_b64 exec, 1
  global_load_ushort v250, v5, s[30:31]
  s_mov_b64 exec, -1
  v_and_b32 v8, 15, v1
  v_mul_u32_u24 v7, 104, v8
  v_add_u32 v7, s13, v7
  v_lshrrev_b32 v9, 2, v1
  v_xor_b32 v9, v9, v1
  v_and_b32 v9, 8, v9
  v_and_b32 v10, 16, v1
  v_add_u32 v4, v9, v10
  s_mov_b32 s38, 0
  s_mov_b32 s91, 0
  v_add_u32 v11, s13, v32
  s_waitcnt vmcnt(2)
  v_and_b32 v9, 8, v12
  v_lshlrev_b32 v12, 5, v12
  v_lshl_or_b32 v12, v9, 1, v12
  v_and_b32 v8, 8, v13
  v_lshlrev_b32 v13, 5, v13
  v_lshl_or_b32 v13, v8, 1, v13
  v_and_b32 v9, 8, v14
  v_lshlrev_b32 v14, 5, v14
  v_lshl_or_b32 v14, v9, 1, v14
  v_and_b32 v8, 8, v15
  v_lshlrev_b32 v15, 5, v15
  v_lshl_or_b32 v15, v8, 1, v15
  ds_write_b128 v11, v[12:15]
  s_waitcnt vmcnt(1)
  v_and_b32 v9, 8, v16
  v_lshlrev_b32 v16, 5, v16
  v_lshl_or_b32 v16, v9, 1, v16
  v_and_b32 v8, 8, v17
  v_lshlrev_b32 v17, 5, v17
  v_lshl_or_b32 v17, v8, 1, v17
  v_and_b32 v9, 8, v18
  v_lshlrev_b32 v18, 5, v18
  v_lshl_or_b32 v18, v9, 1, v18
  v_and_b32 v8, 8, v19
  v_lshlrev_b32 v19, 5, v19
  v_lshl_or_b32 v19, v8, 1, v19
  ds_write_b128 v11, v[16:19] offset:640
  s_waitcnt vmcnt(0) lgkmcnt(0)
  s_barrier
L_C_join:
  ds_read_b64 v[118:119], v7
  ds_read_b64 v[120:121], v7 offset:8
  ds_read_b64 v[122:123], v7 offset:16
  ds_read_b64 v[124:125], v7 offset:24
  ds_read_b64 v[126:127], v7 offset:32
  ds_read_b64 v[128:129], v7 offset:40
  ds_read_b64 v[130:131], v7 offset:48
  ds_read_b64 v[132:133], v7 offset:56
  ds_read_b64 v[134:135], v7 offset:64
  ds_read_b64 v[136:137], v7 offset:72
  ds_read_b64 v[138:139], v7 offset:80
  ds_read_b64 v[140:141], v7 offset:88
  ds_read_b64 v[142:143], v7 offset:96
  s_waitcnt lgkmcnt(7)
  v_xor_b32 v118, v118, v4
  v_xor_b32 v119, v119, v4
  v_xor_b32 v120, v120, v4
  v_xor_b32 v121, v121, v4
  v_xor_b32 v122, v122, v4
  v_xor_b32 v123, v123, v4
  v_xor_b32 v124, v124, v4
  v_xor_b32 v125, v125, v4
  v_xor_b32 v126, v126, v4
  v_xor_b32 v127, v127, v4
  v_xor_b32 v128, v128, v4
  v_xor_b32 v129, v129, v4
  s_waitcnt lgkmcnt(0)
  v_xor_b32 v130, v130, v4
  v_xor_b32 v131, v131, v4
  v_xor_b32 v132, v132, v4
  v_xor_b32 v133, v133, v4
  v_xor_b32 v134, v134, v4
  v_xor_b32 v135, v135, v4
  v_xor_b32 v136, v136, v4
  v_xor_b32 v137, v137, v4
  v_xor_b32 v138, v138, v4
  v_xor_b32 v139, v139, v4
  v_xor_b32 v140, v140, v4
  v_xor_b32 v141, v141, v4
  v_xor_b32 v142, v142, v4
  v_xor_b32 v143, v143, v4
  ds_read_b64 v[40:41], v118
  ds_read_b64 v[66:67], v119
  ds_read_b64 v[42:43], v120
  ds_read_b64 v[68:69], v121
  ds_read_b64 v[44:45], v122
  ds_read_b64 v[70:71], v123
  ds_read_b64 v[46:47], v124
  ds_read_b64 v[72:73], v125
  ds_read_b64 v[48:49], v126
  ds_read_b64 v[74:75], v127
  ds_read_b64 v[50:51], v128
  ds_read_b64 v[76:77], v129
  ds_read_b64 v[52:53], v130
  s_waitcnt lgkmcnt(12)
  v_pk_maximum3_f16 v182, v40, v41, v40
  v_pk_minimum3_f16 v183, v40, v41, v40
  ds_read_b64 v[78:79], v131
  s_waitcnt lgkmcnt(12)
  v_pk_maximum3_f16 v182, v66, v67, v182
  v_pk_minimum3_f16 v183, v66, v67, v183
  ds_read_b64 v[54:55], v132
  s_waitcnt lgkmcnt(12)
  v_pk_maximum3_f16 v182, v42, v43, v182
  v_pk_minimum3_f16 v183, v42, v43, v183
  ds_read_b64 v[80:81], v133
  s_waitcnt lgkmcnt(12)
  v_pk_maximum3_f16 v182, v68, v69, v182
  v_pk_minimum3_f16 v183, v68, v69, v183
  ds_read_b64 v[56:57], v134
  s_waitcnt lgkmcnt(12)
  v_pk_maximum3_f16 v182, v44, v45, v182
  v_pk_minimum3_f16 v183, v44, v45, v183
  ds_read_b64 v[82:83], v135
  s_waitcnt lgkmcnt(12)
  v_pk_maximum3_f16 v182, v70, v71, v182
  v_pk_minimum3_f16 v183, v70, v71, v183
  ds_read_b64 v[58:59], v136
  s_waitcnt lgkmcnt(12)
  v_pk_maximum3_f16 v182, v46, v47, v182
  v_pk_minimum3_f16 v183, v46, v47, v183
  ds_read_b64 v[84:85], v137
  s_waitcnt lgkmcnt(12)
  v_pk_maximum3_f16 v182, v72, v73, v182
  v_pk_minimum3_f16 v183, v72, v73, v183
  s_cmp_eq_u32 s38, 0
  s_cbranch_scc1 L_C_s1
  s_mov_b64 exec, 1
  s_waitcnt vmcnt(0)
  ds_add_rtn_u32 v186, v2, v6 offset:12
  v_mov_b32 v187, s90
  s_mov_b32 s38, 0
  s_waitcnt lgkmcnt(0)
  v_readfirstlane_b32 s5, v186
  s_cmp_lg_u32 s5, 3
  s_cbranch_scc1 L_C_s1b
  buffer_atomic_or v187, v5, s[60:63], 0 offen sc1
L_C_s1b:
  s_mov_b64 exec, -1
L_C_s1:
  ds_read_b64 v[60:61], v138
  s_waitcnt lgkmcnt(12)
  v_pk_maximum3_f16 v182, v48, v49, v182
  v_pk_minimum3_f16 v183, v48, v49, v183
  ds_read_b64 v[86:87], v139
  s_waitcnt lgkmcnt(12)
  v_pk_maximum3_f16 v182, v74, v75, v182
  v_pk_minimum3_f16 v183, v74, v75, v183
  ds_read_b64 v[62:63], v140
  s_waitcnt lgkmcnt(12)
  v_pk_maximum3_f16 v182, v50, v51, v182
  v_pk_minimum3_f16 v183, v50, v51, v183
  ds_read_b64 v[88:89], v141
  s_waitcnt lgkmcnt(12)
  v_pk_maximum3_f16 v182, v76, v77, v182
  v_pk_minimum3_f16 v183, v76, v77, v183
  ds_read_b64 v[64:65], v142
  s_waitcnt lgkmcnt(12)
  v_pk_maximum3_f16 v182, v52, v53, v182
  v_pk_minimum3_f16 v183, v52, v53, v183
  ds_read_b64 v[90:91], v143
  s_waitcnt lgkmcnt(12)
  v_pk_maximum3_f16 v182, v78, v79, v182
  v_pk_minimum3_f16 v183, v78, v79, v183
  s_waitcnt lgkmcnt(11)
  v_pk_maximum3_f16 v182, v54, v55, v182
  v_pk_minimum3_f16 v183, v54, v55, v183
  s_waitcnt lgkmcnt(10)
  v_pk_maximum3_f16 v182, v80, v81, v182
  v_pk_minimum3_f16 v183, v80, v81, v183
  s_waitcnt lgkmcnt(9)
  v_pk_maximum3_f16 v182, v56, v57, v182
  v_pk_minimum3_f16 v183, v56, v57, v183
  s_waitcnt lgkmcnt(8)
  v_pk_maximum3_f16 v182, v82, v83, v182
  v_pk_minimum3_f16 v183, v82, v83, v183
  s_waitcnt lgkmcnt(7)
  v_pk_maximum3_f16 v182, v58, v59, v182
  v_pk_minimum3_f16 v183, v58, v59, v183
  s_waitcnt lgkmcnt(6)
  v_pk_maximum3_f16 v182, v84, v85, v182
  v_pk_minimum3_f16 v183, v84, v85, v183
  s_waitcnt lgkmcnt(5)
  v_pk_maximum3_f16 v182, v60, v61, v182
  v_pk_minimum3_f16 v183, v60, v61, v183
  s_waitcnt lgkmcnt(4)
  v_pk_maximum3_f16 v182, v86, v87, v182
  v_pk_minimum3_f16 v183, v86, v87, v183
  s_waitcnt lgkmcnt(3)
  v_pk_maximum3_f16 v182, v62, v63, v182
  v_pk_minimum3_f16 v183, v62, v63, v183
  s_waitcnt lgkmcnt(2)
  v_pk_maximum3_f16 v182, v88, v89, v182
  v_pk_minimum3_f16 v183, v88, v89, v183
  s_waitcnt lgkmcnt(1)
  v_pk_maximum3_f16 v182, v64, v65, v182
  v_pk_minimum3_f16 v183, v64, v65, v183
  s_waitcnt lgkmcnt(0)
  v_pk_maximum3_f16 v182, v90, v91, v182
  v_pk_minimum3_f16 v183, v90, v91, v183
  v_lshlrev_b32 v250, 16, v250
  v_mul_f32 v250, 0x3e800000, v250
  s_nop 0
  v_readfirstlane_b32 s96, v250
  v_and_b32 v182, 0x7fff7fff, v182
  v_and_b32 v183, 0x7fff7fff, v183
  v_pk_max_u16 v182, v182, v183
  v_lshrrev_b32 v183, 16, v182
  v_and_b32 v182, 0xffff, v182
  v_max_u32 v182, v182, v183
  v_mov_b32 v183, v182
  v_mov_b32 v197, 0xfff8fff8
  s_mov_b32 s12, 0x05040100
  v_permlane32_swap_b32 v182, v183
  v_max_u32 v182, v182, v183
  v_lshrrev_b32 v182, 7, v182
  v_max_u32 v182, 127, v182
  v_min_u32 v182, 254, v182
  v_sub_u32 v183, 260, v182
  v_lshlrev_b32 v4, 23, v183
  v_lshlrev_b32 v182, 2, v182
  v_subrev_u32 v3, 814, v182
  v_cvt_pkrtz_f16_f32 v195, v4, v4
  v_pk_mul_f16 v196, v195, v195
  v_and_b32 v196, 0xffff, v196
  v_lshlrev_b32 v193, 4, v1
  v_lshlrev_b32 v198, 16, v40
  v_lshlrev_b32 v199, 16, v66
  v_mul_f32 v200, v4, v40
  v_mul_f32 v201, v4, v66
  v_mul_f32 v198, v4, v198
  v_mul_f32 v199, v4, v199
  v_cvt_pkrtz_f16_f32 v66, v200, v201
  v_cvt_pkrtz_f16_f32 v40, v198, v199
  v_and_b32 v66, v197, v66
  v_cvt_pkrtz_f16_f32 v20, v199, v198
  v_alignbit_b32 v33, v66, v66, 16
  v_lshlrev_b32 v202, 16, v42
  v_lshlrev_b32 v203, 16, v68
  v_mul_f32 v204, v4, v42
  v_mul_f32 v205, v4, v68
  v_mul_f32 v202, v4, v202
  v_mul_f32 v203, v4, v203
  v_cvt_pkrtz_f16_f32 v68, v204, v205
  v_cvt_pkrtz_f16_f32 v42, v202, v203
  v_and_b32 v68, v197, v68
  v_cvt_pkrtz_f16_f32 v8, v203, v202
  v_alignbit_b32 v21, v68, v68, 16
  v_lshlrev_b32 v206, 16, v44
  v_lshlrev_b32 v207, 16, v70
  v_mul_f32 v208, v4, v44
  v_mul_f32 v209, v4, v70
  v_mul_f32 v206, v4, v206
  v_mul_f32 v207, v4, v207
  v_cvt_pkrtz_f16_f32 v70, v208, v209
  v_cvt_pkrtz_f16_f32 v44, v206, v207
  v_and_b32 v70, v197, v70
  v_cvt_pkrtz_f16_f32 v9, v207, v206
  v_alignbit_b32 v22, v70, v70, 16
  v_permlane32_swap_b32 v40, v8
  v_permlane32_swap_b32 v66, v21
  v_lshlrev_b32 v198, 16, v46
  v_lshlrev_b32 v199, 16, v72
  v_mul_f32 v200, v4, v46
  v_mul_f32 v201, v4, v72
  v_mul_f32 v198, v4, v198
  v_mul_f32 v199, v4, v199
  v_cvt_pkrtz_f16_f32 v72, v200, v201
  v_cvt_pkrtz_f16_f32 v46, v198, v199
  v_and_b32 v72, v197, v72
  v_cvt_pkrtz_f16_f32 v10, v199, v198
  v_alignbit_b32 v23, v72, v72, 16
  v_permlane32_swap_b32 v42, v9
  v_permlane32_swap_b32 v68, v22
  v_lshlrev_b32 v202, 16, v48
  v_lshlrev_b32 v203, 16, v74
  v_mul_f32 v204, v4, v48
  v_mul_f32 v205, v4, v74
  v_mul_f32 v202, v4, v202
  v_mul_f32 v203, v4, v203
  v_cvt_pkrtz_f16_f32 v74, v204, v205
  v_cvt_pkrtz_f16_f32 v48, v202, v203
  v_and_b32 v74, v197, v74
  v_cvt_pkrtz_f16_f32 v11, v203, v202
  v_alignbit_b32 v24, v74, v74, 16
  v_permlane32_swap_b32 v44, v10
  v_permlane32_swap_b32 v70, v23
  v_lshlrev_b32 v206, 16, v50
  v_lshlrev_b32 v207, 16, v76
  v_mul_f32 v208, v4, v50
  v_mul_f32 v209, v4, v76
  v_mul_f32 v206, v4, v206
  v_mul_f32 v207, v4, v207
  v_cvt_pkrtz_f16_f32 v76, v208, v209
  v_cvt_pkrtz_f16_f32 v50, v206, v207
  v_and_b32 v76, v197, v76
  v_cvt_pkrtz_f16_f32 v12, v207, v206
  v_alignbit_b32 v25, v76, v76, 16
  v_permlane32_swap_b32 v46, v11
  v_permlane32_swap_b32 v72, v24
  v_lshlrev_b32 v198, 16, v52
  v_lshlrev_b32 v199, 16, v78
  v_mul_f32 v200, v4, v52
  v_mul_f32 v201, v4, v78
  v_mul_f32 v198, v4, v198
  v_mul_f32 v199, v4, v199
  v_cvt_pkrtz_f16_f32 v78, v200, v201
  v_cvt_pkrtz_f16_f32 v52, v198, v199
  v_and_b32 v78, v197, v78
  v_cvt_pkrtz_f16_f32 v13, v199, v198
  v_alignbit_b32 v26, v78, v78, 16
  v_permlane32_swap_b32 v48, v12
  v_permlane32_swap_b32 v74, v25
  v_lshlrev_b32 v202, 16, v54
  v_lshlrev_b32 v203, 16, v80
  v_mul_f32 v204, v4, v54
  v_mul_f32 v205, v4, v80
  v_mul_f32 v202, v4, v202
  v_mul_f32 v203, v4, v203
  v_cvt_pkrtz_f16_f32 v80, v204, v205
  v_cvt_pkrtz_f16_f32 v54, v202, v203
  v_and_b32 v80, v197, v80
  v_cvt_pkrtz_f16_f32 v14, v203, v202
  v_alignbit_b32 v27, v80, v80, 16
  v_permlane32_swap_b32 v50, v13
  v_permlane32_swap_b32 v76, v26
  v_lshlrev_b32 v206, 16, v56
  v_lshlrev_b32 v207, 16, v82
  v_mul_f32 v208, v4, v56
  v_mul_f32 v209, v4, v82
  v_mul_f32 v206, v4, v206
  v_mul_f32 v207, v4, v207
  v_cvt_pkrtz_f16_f32 v82, v208, v209
  v_cvt_pkrtz_f16_f32 v56, v206, v207
  v_and_b32 v82, v197, v82
  v_cvt_pkrtz_f16_f32 v15, v207, v206
  v_alignbit_b32 v28, v82, v82, 16
  v_permlane32_swap_b32 v52, v14
  v_permlane32_swap_b32 v78, v27
  v_lshlrev_b32 v198, 16, v58
  v_lshlrev_b32 v199, 16, v84
  v_mul_f32 v200, v4, v58
  v_mul_f32 v201, v4, v84
  v_mul_f32 v198, v4, v198
  v_mul_f32 v199, v4, v199
  v_cvt_pkrtz_f16_f32 v84, v200, v201
  v_cvt_pkrtz_f16_f32 v58, v198, v199
  v_and_b32 v84, v197, v84
  v_cvt_pkrtz_f16_f32 v16, v199, v198
  v_alignbit_b32 v29, v84, v84, 16
  v_permlane32_swap_b32 v54, v15
  v_permlane32_swap_b32 v80, v28
  v_lshlrev_b32 v202, 16, v60
  v_lshlrev_b32 v203, 16, v86
  v_mul_f32 v204, v4, v60
  v_mul_f32 v205, v4, v86
  v_mul_f32 v202, v4, v202
  v_mul_f32 v203, v4, v203
  v_cvt_pkrtz_f16_f32 v86, v204, v205
  v_cvt_pkrtz_f16_f32 v60, v202, v203
  v_and_b32 v86, v197, v86
  v_cvt_pkrtz_f16_f32 v17, v203, v202
  v_alignbit_b32 v30, v86, v86, 16
  v_permlane32_swap_b32 v56, v16
  v_permlane32_swap_b32 v82, v29
  v_lshlrev_b32 v206, 16, v62
  v_lshlrev_b32 v207, 16, v88
  v_mul_f32 v208, v4, v62
  v_mul_f32 v209, v4, v88
  v_mul_f32 v206, v4, v206
  v_mul_f32 v207, v4, v207
  v_cvt_pkrtz_f16_f32 v88, v208, v209
  v_cvt_pkrtz_f16_f32 v62, v206, v207
  v_and_b32 v88, v197, v88
  v_cvt_pkrtz_f16_f32 v18, v207, v206
  v_alignbit_b32 v31, v88, v88, 16
  v_permlane32_swap_b32 v58, v17
  v_permlane32_swap_b32 v84, v30
  v_lshlrev_b32 v198, 16, v64
  v_lshlrev_b32 v199, 16, v90
  v_mul_f32 v200, v4, v64
  v_mul_f32 v201, v4, v90
  v_mul_f32 v198, v4, v198
  v_mul_f32 v199, v4, v199
  v_cvt_pkrtz_f16_f32 v90, v200, v201
  v_cvt_pkrtz_f16_f32 v64, v198, v199
  v_and_b32 v90, v197, v90
  v_cvt_pkrtz_f16_f32 v19, v199, v198
  v_alignbit_b32 v32, v90, v90, 16
  v_permlane32_swap_b32 v60, v18
  v_permlane32_swap_b32 v86, v31
  v_permlane32_swap_b32 v64, v20
  v_permlane32_swap_b32 v90, v33
  v_permlane32_swap_b32 v62, v19
  v_permlane32_swap_b32 v88, v32
  v_lshlrev_b32 v246, 16, v41
  v_lshlrev_b32 v247, 16, v67
  v_mul_f32 v248, v4, v41
  v_mul_f32 v249, v4, v67
  v_mul_f32 v246, v4, v246
  v_mul_f32 v247, v4, v247
  v_cvt_pkrtz_f16_f32 v67, v248, v249
  v_cvt_pkrtz_f16_f32 v41, v246, v247
  v_and_b32 v67, v197, v67
  v_cvt_pkrtz_f16_f32 v104, v247, v246
  v_alignbit_b32 v117, v67, v67, 16
  v_lshlrev_b32 v250, 16, v43
  v_lshlrev_b32 v251, 16, v69
  v_mul_f32 v252, v4, v43
  v_mul_f32 v253, v4, v69
  v_mul_f32 v250, v4, v250
  v_mul_f32 v251, v4, v251
  v_cvt_pkrtz_f16_f32 v69, v252, v253
  v_cvt_pkrtz_f16_f32 v43, v250, v251
  v_and_b32 v69, v197, v69
  v_cvt_pkrtz_f16_f32 v92, v251, v250
  v_alignbit_b32 v105, v69, v69, 16
  v_lshlrev_b32 v246, 16, v45
  v_lshlrev_b32 v247, 16, v71
  v_mul_f32 v248, v4, v45
  v_mul_f32 v249, v4, v71
  v_mul_f32 v246, v4, v246
  v_mul_f32 v247, v4, v247
  v_cvt_pkrtz_f16_f32 v71, v248, v249
  v_cvt_pkrtz_f16_f32 v45, v246, v247
  v_and_b32 v71, v197, v71
  v_cvt_pkrtz_f16_f32 v93, v247, v246
  v_alignbit_b32 v106, v71, v71, 16
  v_permlane32_swap_b32 v41, v92
  v_permlane32_swap_b32 v67, v105
  v_lshlrev_b32 v250, 16, v47
  v_lshlrev_b32 v251, 16, v73
  v_mul_f32 v252, v4, v47
  v_mul_f32 v253, v4, v73
  v_mul_f32 v250, v4, v250
  v_mul_f32 v251, v4, v251
  v_cvt_pkrtz_f16_f32 v73, v252, v253
  v_cvt_pkrtz_f16_f32 v47, v250, v251
  v_and_b32 v73, v197, v73
  v_cvt_pkrtz_f16_f32 v94, v251, v250
  v_alignbit_b32 v107, v73, v73, 16
  v_permlane32_swap_b32 v43, v93
  v_permlane32_swap_b32 v69, v106
  v_lshlrev_b32 v246, 16, v49
  v_lshlrev_b32 v247, 16, v75
  v_mul_f32 v248, v4, v49
  v_mul_f32 v249, v4, v75
  v_mul_f32 v246, v4, v246
  v_mul_f32 v247, v4, v247
  v_cvt_pkrtz_f16_f32 v75, v248, v249
  v_cvt_pkrtz_f16_f32 v49, v246, v247
  v_and_b32 v75, v197, v75
  v_cvt_pkrtz_f16_f32 v95, v247, v246
  v_alignbit_b32 v108, v75, v75, 16
  v_permlane32_swap_b32 v45, v94
  v_permlane32_swap_b32 v71, v107
  v_lshlrev_b32 v250, 16, v51
  v_lshlrev_b32 v251, 16, v77
  v_mul_f32 v252, v4, v51
  v_mul_f32 v253, v4, v77
  v_mul_f32 v250, v4, v250
  v_mul_f32 v251, v4, v251
  v_cvt_pkrtz_f16_f32 v77, v252, v253
  v_cvt_pkrtz_f16_f32 v51, v250, v251
  v_and_b32 v77, v197, v77
  v_cvt_pkrtz_f16_f32 v96, v251, v250
  v_alignbit_b32 v109, v77, v77, 16
  v_permlane32_swap_b32 v47, v95
  v_permlane32_swap_b32 v73, v108
  v_lshlrev_b32 v246, 16, v53
  v_lshlrev_b32 v247, 16, v79
  v_mul_f32 v248, v4, v53
  v_mul_f32 v249, v4, v79
  v_mul_f32 v246, v4, v246
  v_mul_f32 v247, v4, v247
  v_cvt_pkrtz_f16_f32 v79, v248, v249
  v_cvt_pkrtz_f16_f32 v53, v246, v247
  v_and_b32 v79, v197, v79
  v_cvt_pkrtz_f16_f32 v97, v247, v246
  v_alignbit_b32 v110, v79, v79, 16
  v_permlane32_swap_b32 v49, v96
  v_permlane32_swap_b32 v75, v109
  v_lshlrev_b32 v250, 16, v55
  v_lshlrev_b32 v251, 16, v81
  v_mul_f32 v252, v4, v55
  v_mul_f32 v253, v4, v81
  v_mul_f32 v250, v4, v250
  v_mul_f32 v251, v4, v251
  v_cvt_pkrtz_f16_f32 v81, v252, v253
  v_cvt_pkrtz_f16_f32 v55, v250, v251
  v_and_b32 v81, v197, v81
  v_cvt_pkrtz_f16_f32 v98, v251, v250
  v_alignbit_b32 v111, v81, v81, 16
  v_permlane32_swap_b32 v51, v97
  v_permlane32_swap_b32 v77, v110
  v_lshlrev_b32 v246, 16, v57
  v_lshlrev_b32 v247, 16, v83
  v_mul_f32 v248, v4, v57
  v_mul_f32 v249, v4, v83
  v_mul_f32 v246, v4, v246
  v_mul_f32 v247, v4, v247
  v_cvt_pkrtz_f16_f32 v83, v248, v249
  v_cvt_pkrtz_f16_f32 v57, v246, v247
  v_and_b32 v83, v197, v83
  v_cvt_pkrtz_f16_f32 v99, v247, v246
  v_alignbit_b32 v112, v83, v83, 16
  v_permlane32_swap_b32 v53, v98
  v_permlane32_swap_b32 v79, v111
  v_lshlrev_b32 v250, 16, v59
  v_lshlrev_b32 v251, 16, v85
  v_mul_f32 v252, v4, v59
  v_mul_f32 v253, v4, v85
  v_mul_f32 v250, v4, v250
  v_mul_f32 v251, v4, v251
  v_cvt_pkrtz_f16_f32 v85, v252, v253
  v_cvt_pkrtz_f16_f32 v59, v250, v251
  v_and_b32 v85, v197, v85
  v_cvt_pkrtz_f16_f32 v100, v251, v250
  v_alignbit_b32 v113, v85, v85, 16
  v_permlane32_swap_b32 v55, v99
  v_permlane32_swap_b32 v81, v112
  v_lshlrev_b32 v246, 16, v61
  v_lshlrev_b32 v247, 16, v87
  v_mul_f32 v248, v4, v61
  buffer_load_dword v194, v5, s[60:63], 0 offen sc1
  v_mul_f32 v249, v4, v87
  v_mul_f32 v246, v4, v246
  v_mul_f32 v247, v4, v247
  v_cvt_pkrtz_f16_f32 v87, v248, v249
  v_cvt_pkrtz_f16_f32 v61, v246, v247
  v_and_b32 v87, v197, v87
  v_cvt_pkrtz_f16_f32 v101, v247, v246
  v_alignbit_b32 v114, v87, v87, 16
  v_permlane32_swap_b32 v57, v100
  v_permlane32_swap_b32 v83, v113
  v_lshlrev_b32 v250, 16, v63
  v_lshlrev_b32 v251, 16, v89
  v_mul_f32 v252, v4, v63
  v_mul_f32 v253, v4, v89
  v_mul_f32 v250, v4, v250
  v_mul_f32 v251, v4, v251
  v_cvt_pkrtz_f16_f32 v89, v252, v253
  v_cvt_pkrtz_f16_f32 v63, v250, v251
  v_and_b32 v89, v197, v89
  v_cvt_pkrtz_f16_f32 v102, v251, v250
  v_alignbit_b32 v115, v89, v89, 16
  v_permlane32_swap_b32 v59, v101
  v_permlane32_swap_b32 v85, v114
  v_lshlrev_b32 v246, 16, v65
  v_lshlrev_b32 v247, 16, v91
  v_mul_f32 v248, v4, v65
  v_mul_f32 v249, v4, v91
  v_mul_f32 v246, v4, v246
  v_mul_f32 v247, v4, v247
  v_cvt_pkrtz_f16_f32 v91, v248, v249
  v_cvt_pkrtz_f16_f32 v65, v246, v247
  v_and_b32 v91, v197, v91
  v_cvt_pkrtz_f16_f32 v103, v247, v246
  v_alignbit_b32 v116, v91, v91, 16
  v_permlane32_swap_b32 v61, v102
  v_permlane32_swap_b32 v87, v115
  v_permlane32_swap_b32 v65, v104
  v_permlane32_swap_b32 v91, v117
  v_permlane32_swap_b32 v63, v103
  v_permlane32_swap_b32 v89, v116
  v_and_b32 v192, 31, v1
  v_lshrrev_b32 v191, 5, v1
  v_cmp_eq_u32 vcc, 28, v192
  v_cmp_gt_u32 s[14:15], 25, v192
  v_mov_b32 v190, 26
  v_mov_b32 v189, 25
  v_cndmask_b32 v190, v190, v189, vcc
  v_cndmask_b32 v192, v190, v192, s[14:15]
  v_mul_u32_u24 v192, 784, v192
  v_mul_u32_u24 v191, 384, v191
  v_add3_u32 v7, v192, v191, v5
  v_add_u32 v7, 39936, v7
  s_setprio 3
  s_waitcnt vmcnt(0)
  v_readfirstlane_b32 s5, v194
  s_cmp_lg_u32 s5, 0x3fff
  s_cbranch_scc1 L_C_notyet
L_C_ready:
  s_cmp_lg_u32 s3, 0
  s_cbranch_scc1 L_C_nr
  ds_write_b32 v2, v6 offset:16
L_C_nr:
  s_lshr_b32 s8, s2, 3
  s_and_b32 s9, s8, 3
  s_mul_i32 s13, s3, 11264
  s_cmp_eq_u32 s9, 3
  s_cselect_b32 s9, 0, s9
  s_lshl_b32 s9, s9, 12
  s_add_u32 s11, s13, s9
  s_add_u32 m0, s11, 39936
  s_cmp_eq_u32 s9, 8192
  buffer_load_dwordx4 v193, s[52:55], s11 offen offset:0 sc1 lds
  buffer_load_dwordx4 v193, s[52:55], s11 offen offset:1024 sc1 lds
  buffer_load_dwordx4 v193, s[52:55], s11 offen offset:2048 sc1 lds
  s_cbranch_scc1 L_al0
  buffer_load_dwordx4 v193, s[52:55], s11 offen offset:3072 sc1 lds
L_al0:
  s_cselect_b32 s9, -4096, s9
  s_add_u32 s9, s9, 4096
  s_add_u32 s11, s13, s9
  s_add_u32 m0, s11, 39936
  s_cmp_eq_u32 s9, 8192
  buffer_load_dwordx4 v193, s[52:55], s11 offen offset:0 sc1 lds
  buffer_load_dwordx4 v193, s[52:55], s11 offen offset:1024 sc1 lds
  buffer_load_dwordx4 v193, s[52:55], s11 offen offset:2048 sc1 lds
  s_cbranch_scc1 L_al1
  buffer_load_dwordx4 v193, s[52:55], s11 offen offset:3072 sc1 lds
L_al1:
  s_cselect_b32 s9, -4096, s9
  s_add_u32 s9, s9, 4096
  s_add_u32 s11, s13, s9
  s_add_u32 m0, s11, 39936
  s_cmp_eq_u32 s9, 8192
  buffer_load_dwordx4 v193, s[52:55], s11 offen offset:0 sc1 lds
  buffer_load_dwordx4 v193, s[52:55], s11 offen offset:1024 sc1 lds
  buffer_load_dwordx4 v193, s[52:55], s11 offen offset:2048 sc1 lds
  s_cbranch_scc1 L_al2
  buffer_load_dwordx4 v193, s[52:55], s11 offen offset:3072 sc1 lds
L_al2:
  s_setprio 0
  v_mov_b32 v182, 0
  v_mov_b32 v183, 0
  v_mov_b32 v184, 0
  v_mov_b32 v185, 0
  v_mov_b32 v186, 0
  v_mov_b32 v187, 0
  v_mov_b32 v188, 0
  v_mov_b32 v189, 0
  v_mov_b32 v190, 0
  v_mov_b32 v191, 0
  v_mov_b32 v192, 0
  v_mov_b32 v193, 0
  v_mov_b32 v194, 0
  v_pk_mul_f16 v198, v8, v195
  v_pk_mul_f16 v199, v10, v195
  v_pk_mul_f16 v200, v12, v195
  v_pk_mul_f16 v201, v14, v195
  v_pk_mul_f16 v202, v21, v195
  v_pk_mul_f16 v203, v23, v195
  v_pk_mul_f16 v204, v25, v195
  v_pk_mul_f16 v205, v27, v195
  s_waitcnt vmcnt(0)
  s_mov_b64 exec, 1
  ds_add_u32 v2, v6
  s_mov_b64 exec, -1
  s_setprio 0
L_C_w2:
  ds_read_b32 v255, v2
  s_waitcnt lgkmcnt(0)
  v_readfirstlane_b32 s5, v255
  s_cmp_lt_u32 s5, 4
  s_cbranch_scc1 L_C_w2
L_C_go:
  s_setprio 1
  ds_read_b128 v[234:237], v7 offset:21520
  ds_read_b128 v[238:241], v7 offset:21536
  ds_read_b128 v[242:245], v7
  ds_read_b128 v[246:249], v7 offset:21168
  s_waitcnt lgkmcnt(3)
  v_mfma_f32_32x32x16_f16 v[134:149], v[234:237], v[198:201], 0
  v_pk_mul_f16 v206, v16, v195
  v_pk_mul_f16 v207, v18, v195
  v_pk_mul_f16 v208, v20, v195
  v_mov_b32 v209, v196
  v_mfma_f32_32x32x16_f16 v[166:181], v[234:237], v[202:205], 0
  v_pk_mul_f16 v210, v29, v195
  v_pk_mul_f16 v211, v31, v195
  v_pk_mul_f16 v212, v33, v195
  v_mov_b32 v213, v196
  ds_read_b128 v[250:253], v7 offset:16
  s_waitcnt lgkmcnt(3)
  v_mfma_f32_32x32x16_f16 v[134:149], v[238:241], v[206:209], v[134:149]
  v_pk_mul_f16 v198, v8, v9 op_sel:[0,0] op_sel_hi:[0,1]
  v_pk_mul_f16 v199, v8, v10 op_sel:[0,0] op_sel_hi:[0,1]
  v_pk_mul_f16 v200, v8, v11 op_sel:[0,0] op_sel_hi:[0,1]
  v_pk_mul_f16 v201, v8, v12 op_sel:[0,0] op_sel_hi:[0,1]
  v_mfma_f32_32x32x16_f16 v[166:181], v[238:241], v[210:213], v[166:181]
  v_pk_mul_f16 v202, v21, v22 op_sel:[0,0] op_sel_hi:[0,1]
  v_pk_mul_f16 v203, v21, v23 op_sel:[0,0] op_sel_hi:[0,1]
  v_pk_mul_f16 v204, v21, v24 op_sel:[0,0] op_sel_hi:[0,1]
  v_pk_mul_f16 v205, v21, v25 op_sel:[0,0] op_sel_hi:[0,1]
  ds_read_b128 v[214:217], v7 offset:21184
  s_waitcnt lgkmcnt(2)
  v_mfma_f32_32x32x16_f16 v[118:133], v[242:245], v[198:201], 0
  v_pk_mul_f16 v206, v8, v13 op_sel:[0,0] op_sel_hi:[0,1]
  v_pk_mul_f16 v207, v8, v14 op_sel:[0,0] op_sel_hi:[0,1]
  v_mfma_f32_32x32x16_f16 v[134:149], v[246:249], v[198:201], v[134:149]
  v_pk_mul_f16 v208, v9, v10 op_sel:[0,0] op_sel_hi:[0,1]
  v_pk_mul_f16 v209, v9, v11 op_sel:[0,0] op_sel_hi:[0,1]
  ds_read_b128 v[218:221], v7 offset:32
  v_mfma_f32_32x32x16_f16 v[166:181], v[246:249], v[202:205], v[166:181]
  v_pk_mul_f16 v210, v21, v26 op_sel:[0,0] op_sel_hi:[0,1]
  v_pk_mul_f16 v211, v21, v27 op_sel:[0,0] op_sel_hi:[0,1]
  v_pk_mul_f16 v212, v22, v23 op_sel:[0,0] op_sel_hi:[0,1]
  v_mfma_f32_32x32x16_f16 v[150:165], v[242:245], v[202:205], 0
  v_pk_mul_f16 v213, v22, v24 op_sel:[0,0] op_sel_hi:[0,1]
  ds_read_b128 v[222:225], v7 offset:21200
  s_waitcnt lgkmcnt(2)
  v_mfma_f32_32x32x16_f16 v[118:133], v[250:253], v[206:209], v[118:133]
  v_pk_mul_f16 v198, v9, v12 op_sel:[0,0] op_sel_hi:[0,1]
  v_pk_mul_f16 v199, v9, v13 op_sel:[0,0] op_sel_hi:[0,1]
  v_mfma_f32_32x32x16_f16 v[134:149], v[214:217], v[206:209], v[134:149]
  v_pk_mul_f16 v200, v9, v14 op_sel:[0,0] op_sel_hi:[0,1]
  v_pk_mul_f16 v201, v9, v15 op_sel:[0,0] op_sel_hi:[0,1]
  ds_read_b128 v[226:229], v7 offset:48
  v_mfma_f32_32x32x16_f16 v[166:181], v[214:217], v[210:213], v[166:181]
  v_pk_mul_f16 v202, v22, v25 op_sel:[0,0] op_sel_hi:[0,1]
  v_pk_mul_f16 v203, v22, v26 op_sel:[0,0] op_sel_hi:[0,1]
  v_pk_mul_f16 v204, v22, v27 op_sel:[0,0] op_sel_hi:[0,1]
  v_mfma_f32_32x32x16_f16 v[150:165], v[250:253], v[210:213], v[150:165]
  v_pk_mul_f16 v205, v22, v28 op_sel:[0,0] op_sel_hi:[0,1]
  ds_read_b128 v[230:233], v7 offset:21216
  s_waitcnt lgkmcnt(2)
  v_mfma_f32_32x32x16_f16 v[118:133], v[218:221], v[198:201], v[118:133]
  v_pk_mul_f16 v206, v10, v11 op_sel:[0,0] op_sel_hi:[0,1]
  v_pk_mul_f16 v207, v10, v12 op_sel:[0,0] op_sel_hi:[0,1]
  v_mfma_f32_32x32x16_f16 v[134:149], v[222:225], v[198:201], v[134:149]
  v_pk_mul_f16 v208, v10, v13 op_sel:[0,0] op_sel_hi:[0,1]
  v_pk_mul_f16 v209, v10, v14 op_sel:[0,0] op_sel_hi:[0,1]
  ds_read_b128 v[214:217], v7 offset:64
  v_mfma_f32_32x32x16_f16 v[166:181], v[222:225], v[202:205], v[166:181]
  v_pk_mul_f16 v210, v23, v24 op_sel:[0,0] op_sel_hi:[0,1]
  v_pk_mul_f16 v211, v23, v25 op_sel:[0,0] op_sel_hi:[0,1]
  v_pk_mul_f16 v212, v23, v26 op_sel:[0,0] op_sel_hi:[0,1]
  v_mfma_f32_32x32x16_f16 v[150:165], v[218:221], v[202:205], v[150:165]
  v_pk_mul_f16 v213, v23, v27 op_sel:[0,0] op_sel_hi:[0,1]
  ds_read_b128 v[218:221], v7 offset:21232
  s_waitcnt lgkmcnt(2)
  v_mfma_f32_32x32x16_f16 v[118:133], v[226:229], v[206:209], v[118:133]
  v_pk_mul_f16 v198, v10, v15 op_sel:[0,0] op_sel_hi:[0,1]
  v_pk_mul_f16 v199, v10, v16 op_sel:[0,0] op_sel_hi:[0,1]
  v_mfma_f32_32x32x16_f16 v[134:149], v[230:233], v[206:209], v[134:149]
  v_pk_mul_f16 v200, v11, v12 op_sel:[0,0] op_sel_hi:[0,1]
  v_pk_mul_f16 v201, v11, v13 op_sel:[0,0] op_sel_hi:[0,1]
  ds_read_b128 v[222:225], v7 offset:80
  v_mfma_f32_32x32x16_f16 v[166:181], v[230:233], v[210:213], v[166:181]
  v_pk_mul_f16 v202, v23, v28 op_sel:[0,0] op_sel_hi:[0,1]
  v_pk_mul_f16 v203, v23, v29 op_sel:[0,0] op_sel_hi:[0,1]
  v_pk_mul_f16 v204, v24, v25 op_sel:[0,0] op_sel_hi:[0,1]
  v_mfma_f32_32x32x16_f16 v[150:165], v[226:229], v[210:213], v[150:165]
  v_pk_mul_f16 v205, v24, v26 op_sel:[0,0] op_sel_hi:[0,1]
  ds_read_b128 v[226:229], v7 offset:21248
  s_waitcnt lgkmcnt(2)
  v_mfma_f32_32x32x16_f16 v[118:133], v[214:217], v[198:201], v[118:133]
  v_pk_mul_f16 v206, v11, v14 op_sel:[0,0] op_sel_hi:[0,1]
  v_pk_mul_f16 v207, v11, v15 op_sel:[0,0] op_sel_hi:[0,1]
  v_mfma_f32_32x32x16_f16 v[134:149], v[218:221], v[198:201], v[134:149]
  v_pk_mul_f16 v208, v11, v16 op_sel:[0,0] op_sel_hi:[0,1]
  v_pk_mul_f16 v209, v11, v17 op_sel:[0,0] op_sel_hi:[0,1]
  ds_read_b128 v[230:233], v7 offset:96
  v_mfma_f32_32x32x16_f16 v[166:181], v[218:221], v[202:205], v[166:181]
  v_pk_mul_f16 v210, v24, v27 op_sel:[0,0] op_sel_hi:[0,1]
  v_pk_mul_f16 v211, v24, v28 op_sel:[0,0] op_sel_hi:[0,1]
  v_pk_mul_f16 v212, v24, v29 op_sel:[0,0] op_sel_hi:[0,1]
  v_mfma_f32_32x32x16_f16 v[150:165], v[214:217], v[202:205], v[150:165]
  v_pk_mul_f16 v213, v24, v30 op_sel:[0,0] op_sel_hi:[0,1]
  ds_read_b128 v[214:217], v7 offset:21264
  s_waitcnt lgkmcnt(2)
  v_mfma_f32_32x32x16_f16 v[118:133], v[222:225], v[206:209], v[118:133]
  v_pk_mul_f16 v198, v12, v13 op_sel:[0,0] op_sel_hi:[0,1]
  v_pk_mul_f16 v199, v12, v14 op_sel:[0,0] op_sel_hi:[0,1]
  v_mfma_f32_32x32x16_f16 v[134:149], v[226:229], v[206:209], v[134:149]
  v_pk_mul_f16 v200, v12, v15 op_sel:[0,0] op_sel_hi:[0,1]
  v_pk_mul_f16 v201, v12, v16 op_sel:[0,0] op_sel_hi:[0,1]
  ds_read_b128 v[218:221], v7 offset:112
  v_mfma_f32_32x32x16_f16 v[166:181], v[226:229], v[210:213], v[166:181]
  v_pk_mul_f16 v202, v25, v26 op_sel:[0,0] op_sel_hi:[0,1]
  v_pk_mul_f16 v203, v25, v27 op_sel:[0,0] op_sel_hi:[0,1]
  v_pk_mul_f16 v204, v25, v28 op_sel:[0,0] op_sel_hi:[0,1]
  v_mfma_f32_32x32x16_f16 v[150:165], v[222:225], v[210:213], v[150:165]
  v_pk_mul_f16 v205, v25, v29 op_sel:[0,0] op_sel_hi:[0,1]
  ds_read_b128 v[222:225], v7 offset:21280
  s_waitcnt lgkmcnt(2)
  v_mfma_f32_32x32x16_f16 v[118:133], v[230:233], v[198:201], v[118:133]
  v_pk_mul_f16 v206, v12, v17 op_sel:[0,0] op_sel_hi:[0,1]
  v_pk_mul_f16 v207, v12, v18 op_sel:[0,0] op_sel_hi:[0,1]
  v_mfma_f32_32x32x16_f16 v[134:149], v[214:217], v[198:201], v[134:149]
  v_pk_mul_f16 v208, v13, v14 op_sel:[0,0] op_sel_hi:[0,1]
  v_pk_mul_f16 v209, v13, v15 op_sel:[0,0] op_sel_hi:[0,1]
  ds_read_b128 v[226:229], v7 offset:128
  v_mfma_f32_32x32x16_f16 v[166:181], v[214:217], v[202:205], v[166:181]
  v_pk_mul_f16 v210, v25, v30 op_sel:[0,0] op_sel_hi:[0,1]
  v_pk_mul_f16 v211, v25, v31 op_sel:[0,0] op_sel_hi:[0,1]
  v_pk_mul_f16 v212, v26, v27 op_sel:[0,0] op_sel_hi:[0,1]
  v_mfma_f32_32x32x16_f16 v[150:165], v[230:233], v[202:205], v[150:165]
  v_pk_mul_f16 v213, v26, v28 op_sel:[0,0] op_sel_hi:[0,1]
  ds_read_b128 v[230:233], v7 offset:21296
  s_waitcnt lgkmcnt(2)
  v_mfma_f32_32x32x16_f16 v[118:133], v[218:221], v[206:209], v[118:133]
  v_pk_mul_f16 v198, v13, v16 op_sel:[0,0] op_sel_hi:[0,1]
  v_pk_mul_f16 v199, v13, v17 op_sel:[0,0] op_sel_hi:[0,1]
  v_mfma_f32_32x32x16_f16 v[134:149], v[222:225], v[206:209], v[134:149]
  v_pk_mul_f16 v200, v13, v18 op_sel:[0,0] op_sel_hi:[0,1]
  v_pk_mul_f16 v201, v13, v19 op_sel:[0,0] op_sel_hi:[0,1]
  ds_read_b128 v[214:217], v7 offset:144
  v_mfma_f32_32x32x16_f16 v[166:181], v[222:225], v[210:213], v[166:181]
  v_pk_mul_f16 v202, v26, v29 op_sel:[0,0] op_sel_hi:[0,1]
  v_pk_mul_f16 v203, v26, v30 op_sel:[0,0] op_sel_hi:[0,1]
  v_pk_mul_f16 v204, v26, v31 op_sel:[0,0] op_sel_hi:[0,1]
  v_mfma_f32_32x32x16_f16 v[150:165], v[218:221], v[210:213], v[150:165]
  v_pk_mul_f16 v205, v26, v32 op_sel:[0,0] op_sel_hi:[0,1]
  ds_read_b128 v[218:221], v7 offset:21312
  s_waitcnt lgkmcnt(2)
  v_mfma_f32_32x32x16_f16 v[118:133], v[226:229], v[198:201], v[118:133]
  v_pk_mul_f16 v206, v14, v15 op_sel:[0,0] op_sel_hi:[0,1]
  v_pk_mul_f16 v207, v14, v16 op_sel:[0,0] op_sel_hi:[0,1]
  v_mfma_f32_32x32x16_f16 v[134:149], v[230:233], v[198:201], v[134:149]
  v_pk_mul_f16 v208, v14, v17 op_sel:[0,0] op_sel_hi:[0,1]
  v_pk_mul_f16 v209, v14, v18 op_sel:[0,0] op_sel_hi:[0,1]
  ds_read_b128 v[222:225], v7 offset:160
  v_mfma_f32_32x32x16_f16 v[166:181], v[230:233], v[202:205], v[166:181]
  v_pk_mul_f16 v210, v27, v28 op_sel:[0,0] op_sel_hi:[0,1]
  v_pk_mul_f16 v211, v27, v29 op_sel:[0,0] op_sel_hi:[0,1]
  v_pk_mul_f16 v212, v27, v30 op_sel:[0,0] op_sel_hi:[0,1]
  v_mfma_f32_32x32x16_f16 v[150:165], v[226:229], v[202:205], v[150:165]
  v_pk_mul_f16 v213, v27, v31 op_sel:[0,0] op_sel_hi:[0,1]
  ds_read_b128 v[226:229], v7 offset:21328
  s_waitcnt lgkmcnt(2)
  v_mfma_f32_32x32x16_f16 v[118:133], v[214:217], v[206:209], v[118:133]
  v_pk_mul_f16 v198, v14, v19 op_sel:[0,0] op_sel_hi:[0,1]
  v_pk_mul_f16 v199, v14, v20 op_sel:[0,0] op_sel_hi:[0,1]
  v_mfma_f32_32x32x16_f16 v[134:149], v[218:221], v[206:209], v[134:149]
  v_pk_mul_f16 v200, v15, v16 op_sel:[0,0] op_sel_hi:[0,1]
  v_pk_mul_f16 v201, v15, v17 op_sel:[0,0] op_sel_hi:[0,1]
  ds_read_b128 v[230:233], v7 offset:176
  v_mfma_f32_32x32x16_f16 v[166:181], v[218:221], v[210:213], v[166:181]
  v_pk_mul_f16 v202, v27, v32 op_sel:[0,0] op_sel_hi:[0,1]
  v_pk_mul_f16 v203, v27, v33 op_sel:[0,0] op_sel_hi:[0,1]
  v_pk_mul_f16 v204, v28, v29 op_sel:[0,0] op_sel_hi:[0,1]
  v_mfma_f32_32x32x16_f16 v[150:165], v[214:217], v[210:213], v[150:165]
  v_pk_mul_f16 v205, v28, v30 op_sel:[0,0] op_sel_hi:[0,1]
  ds_read_b128 v[214:217], v7 offset:21344
  s_waitcnt lgkmcnt(2)
  v_mfma_f32_32x32x16_f16 v[118:133], v[222:225], v[198:201], v[118:133]
  v_pk_mul_f16 v206, v15, v18 op_sel:[0,0] op_sel_hi:[0,1]
  v_pk_mul_f16 v207, v15, v19 op_sel:[0,0] op_sel_hi:[0,1]
  v_mfma_f32_32x32x16_f16 v[134:149], v[226:229], v[198:201], v[134:149]
  v_pk_mul_f16 v208, v15, v20 op_sel:[0,0] op_sel_hi:[0,1]
  v_pk_mul_f16 v209, v15, v8 op_sel:[0,0] op_sel_hi:[0,1]
  ds_read_b128 v[218:221], v7 offset:192
  v_mfma_f32_32x32x16_f16 v[166:181], v[226:229], v[202:205], v[166:181]
  v_pk_mul_f16 v210, v28, v31 op_sel:[0,0] op_sel_hi:[0,1]
  v_pk_mul_f16 v211, v28, v32 op_sel:[0,0] op_sel_hi:[0,1]
  v_pk_mul_f16 v212, v28, v33 op_sel:[0,0] op_sel_hi:[0,1]
  v_mfma_f32_32x32x16_f16 v[150:165], v[222:225], v[202:205], v[150:165]
  v_pk_mul_f16 v213, v28, v21 op_sel:[0,0] op_sel_hi:[0,1]
  ds_read_b128 v[222:225], v7 offset:21360
  s_waitcnt lgkmcnt(2)
  v_mfma_f32_32x32x16_f16 v[118:133], v[230:233], v[206:209], v[118:133]
  v_pk_mul_f16 v198, v16, v17 op_sel:[0,0] op_sel_hi:[0,1]
  v_pk_mul_f16 v199, v16, v18 op_sel:[0,0] op_sel_hi:[0,1]
  v_mfma_f32_32x32x16_f16 v[134:149], v[214:217], v[206:209], v[134:149]
  v_pk_mul_f16 v200, v16, v19 op_sel:[0,0] op_sel_hi:[0,1]
  v_pk_mul_f16 v201, v16, v20 op_sel:[0,0] op_sel_hi:[0,1]
  ds_read_b128 v[226:229], v7 offset:208
  v_mfma_f32_32x32x16_f16 v[166:181], v[214:217], v[210:213], v[166:181]
  v_pk_mul_f16 v202, v29, v30 op_sel:[0,0] op_sel_hi:[0,1]
  v_pk_mul_f16 v203, v29, v31 op_sel:[0,0] op_sel_hi:[0,1]
  v_pk_mul_f16 v204, v29, v32 op_sel:[0,0] op_sel_hi:[0,1]
  v_mfma_f32_32x32x16_f16 v[150:165], v[230:233], v[210:213], v[150:165]
  v_pk_mul_f16 v205, v29, v33 op_sel:[0,0] op_sel_hi:[0,1]
  ds_read_b128 v[230:233], v7 offset:21376
  s_waitcnt lgkmcnt(2)
  v_mfma_f32_32x32x16_f16 v[118:133], v[218:221], v[198:201], v[118:133]
  v_pk_mul_f16 v206, v16, v8 op_sel:[0,0] op_sel_hi:[0,1]
  v_pk_mul_f16 v207, v16, v9 op_sel:[0,0] op_sel_hi:[0,1]
  v_mfma_f32_32x32x16_f16 v[134:149], v[222:225], v[198:201], v[134:149]
  v_pk_mul_f16 v208, v17, v18 op_sel:[0,0] op_sel_hi:[0,1]
  v_pk_mul_f16 v209, v17, v19 op_sel:[0,0] op_sel_hi:[0,1]
  ds_read_b128 v[214:217], v7 offset:224
  v_mfma_f32_32x32x16_f16 v[166:181], v[222:225], v[202:205], v[166:181]
  v_pk_mul_f16 v210, v29, v21 op_sel:[0,0] op_sel_hi:[0,1]
  v_pk_mul_f16 v211, v29, v22 op_sel:[0,0] op_sel_hi:[0,1]
  v_pk_mul_f16 v212, v30, v31 op_sel:[0,0] op_sel_hi:[0,1]
  v_mfma_f32_32x32x16_f16 v[150:165], v[218:221], v[202:205], v[150:165]
  v_pk_mul_f16 v213, v30, v32 op_sel:[0,0] op_sel_hi:[0,1]
  ds_read_b128 v[218:221], v7 offset:21392
  s_waitcnt lgkmcnt(2)
  v_mfma_f32_32x32x16_f16 v[118:133], v[226:229], v[206:209], v[118:133]
  v_pk_mul_f16 v198, v17, v20 op_sel:[0,0] op_sel_hi:[0,1]
  v_pk_mul_f16 v199, v17, v8 op_sel:[0,0] op_sel_hi:[0,1]
  v_mfma_f32_32x32x16_f16 v[134:149], v[230:233], v[206:209], v[134:149]
  v_pk_mul_f16 v200, v17, v9 op_sel:[0,0] op_sel_hi:[0,1]
  v_pk_mul_f16 v201, v17, v10 op_sel:[0,0] op_sel_hi:[0,1]
  ds_read_b128 v[222:225], v7 offset:240
  v_mfma_f32_32x32x16_f16 v[166:181], v[230:233], v[210:213], v[166:181]
  v_pk_mul_f16 v202, v30, v33 op_sel:[0,0] op_sel_hi:[0,1]
  v_pk_mul_f16 v203, v30, v21 op_sel:[0,0] op_sel_hi:[0,1]
  v_pk_mul_f16 v204, v30, v22 op_sel:[0,0] op_sel_hi:[0,1]
  v_mfma_f32_32x32x16_f16 v[150:165], v[226:229], v[210:213], v[150:165]
  v_pk_mul_f16 v205, v30, v23 op_sel:[0,0] op_sel_hi:[0,1]
  ds_read_b128 v[226:229], v7 offset:21408
  s_waitcnt lgkmcnt(2)
  v_mfma_f32_32x32x16_f16 v[118:133], v[214:217], v[198:201], v[118:133]
  v_pk_mul_f16 v206, v18, v19 op_sel:[0,0] op_sel_hi:[0,1]
  v_pk_mul_f16 v207, v18, v20 op_sel:[0,0] op_sel_hi:[0,1]
  v_mfma_f32_32x32x16_f16 v[134:149], v[218:221], v[198:201], v[134:149]
  v_pk_mul_f16 v208, v18, v8 op_sel:[0,0] op_sel_hi:[0,1]
  v_pk_mul_f16 v209, v18, v9 op_sel:[0,0] op_sel_hi:[0,1]
  ds_read_b128 v[230:233], v7 offset:256
  v_mfma_f32_32x32x16_f16 v[166:181], v[218:221], v[202:205], v[166:181]
  v_pk_mul_f16 v210, v31, v32 op_sel:[0,0] op_sel_hi:[0,1]
  v_pk_mul_f16 v211, v31, v33 op_sel:[0,0] op_sel_hi:[0,1]
  v_pk_mul_f16 v212, v31, v21 op_sel:[0,0] op_sel_hi:[0,1]
  v_mfma_f32_32x32x16_f16 v[150:165], v[214:217], v[202:205], v[150:165]
  v_pk_mul_f16 v213, v31, v22 op_sel:[0,0] op_sel_hi:[0,1]
  ds_read_b128 v[214:217], v7 offset:21424
  s_waitcnt lgkmcnt(2)
  v_mfma_f32_32x32x16_f16 v[118:133], v[222:225], v[206:209], v[118:133]
  v_pk_mul_f16 v198, v18, v10 op_sel:[0,0] op_sel_hi:[0,1]
  v_pk_mul_f16 v199, v18, v11 op_sel:[0,0] op_sel_hi:[0,1]
  v_mfma_f32_32x32x16_f16 v[134:149], v[226:229], v[206:209], v[134:149]
  v_pk_mul_f16 v200, v19, v20 op_sel:[0,0] op_sel_hi:[0,1]
  v_pk_mul_f16 v201, v19, v8 op_sel:[0,0] op_sel_hi:[0,1]
  ds_read_b128 v[218:221], v7 offset:272
  v_mfma_f32_32x32x16_f16 v[166:181], v[226:229], v[210:213], v[166:181]
  v_pk_mul_f16 v202, v31, v23 op_sel:[0,0] op_sel_hi:[0,1]
  v_pk_mul_f16 v203, v31, v24 op_sel:[0,0] op_sel_hi:[0,1]
  v_pk_mul_f16 v204, v32, v33 op_sel:[0,0] op_sel_hi:[0,1]
  v_mfma_f32_32x32x16_f16 v[150:165], v[222:225], v[210:213], v[150:165]
  v_pk_mul_f16 v205, v32, v21 op_sel:[0,0] op_sel_hi:[0,1]
  ds_read_b128 v[222:225], v7 offset:21440
  s_waitcnt lgkmcnt(2)
  v_mfma_f32_32x32x16_f16 v[118:133], v[230:233], v[198:201], v[118:133]
  v_pk_mul_f16 v206, v19, v9 op_sel:[0,0] op_sel_hi:[0,1]
  v_pk_mul_f16 v207, v19, v10 op_sel:[0,0] op_sel_hi:[0,1]
  v_mfma_f32_32x32x16_f16 v[134:149], v[214:217], v[198:201], v[134:149]
  v_pk_mul_f16 v208, v19, v11 op_sel:[0,0] op_sel_hi:[0,1]
  v_pk_mul_f16 v209, v19, v12 op_sel:[0,0] op_sel_hi:[0,1]
  ds_read_b128 v[226:229], v7 offset:288
  v_mfma_f32_32x32x16_f16 v[166:181], v[214:217], v[202:205], v[166:181]
  v_pk_mul_f16 v210, v32, v22 op_sel:[0,0] op_sel_hi:[0,1]
  v_pk_mul_f16 v211, v32, v23 op_sel:[0,0] op_sel_hi:[0,1]
  v_pk_mul_f16 v212, v32, v24 op_sel:[0,0] op_sel_hi:[0,1]
  v_mfma_f32_32x32x16_f16 v[150:165], v[230:233], v[202:205], v[150:165]
  v_pk_mul_f16 v213, v32, v25 op_sel:[0,0] op_sel_hi:[0,1]
  ds_read_b128 v[230:233], v7 offset:21456
  s_waitcnt lgkmcnt(2)
  v_mfma_f32_32x32x16_f16 v[118:133], v[218:221], v[206:209], v[118:133]
  v_pk_mul_f16 v198, v20, v8 op_sel:[0,0] op_sel_hi:[0,1]
  v_pk_mul_f16 v199, v20, v9 op_sel:[0,0] op_sel_hi:[0,1]
  v_mfma_f32_32x32x16_f16 v[134:149], v[222:225], v[206:209], v[134:149]
  v_pk_mul_f16 v200, v20, v10 op_sel:[0,0] op_sel_hi:[0,1]
  v_pk_mul_f16 v201, v20, v11 op_sel:[0,0] op_sel_hi:[0,1]
  ds_read_b128 v[214:217], v7 offset:304
  v_mfma_f32_32x32x16_f16 v[166:181], v[222:225], v[210:213], v[166:181]
  v_pk_mul_f16 v202, v33, v21 op_sel:[0,0] op_sel_hi:[0,1]
  v_pk_mul_f16 v203, v33, v22 op_sel:[0,0] op_sel_hi:[0,1]
  v_pk_mul_f16 v204, v33, v23 op_sel:[0,0] op_sel_hi:[0,1]
  v_mfma_f32_32x32x16_f16 v[150:165], v[218:221], v[210:213], v[150:165]
  v_pk_mul_f16 v205, v33, v24 op_sel:[0,0] op_sel_hi:[0,1]
  ds_read_b128 v[218:221], v7 offset:21472
  s_waitcnt lgkmcnt(2)
  v_mfma_f32_32x32x16_f16 v[118:133], v[226:229], v[198:201], v[118:133]
  v_pk_mul_f16 v206, v20, v12 op_sel:[0,0] op_sel_hi:[0,1]
  v_pk_mul_f16 v207, v20, v13 op_sel:[0,0] op_sel_hi:[0,1]
  v_mfma_f32_32x32x16_f16 v[134:149], v[230:233], v[198:201], v[134:149]
  v_pk_mul_f16 v208, v8, v8 op_sel:[0,0] op_sel_hi:[0,1]
  v_pk_mul_f16 v209, v10, v10 op_sel:[0,0] op_sel_hi:[0,1]
  ds_read_b128 v[222:225], v7 offset:320
  v_mfma_f32_32x32x16_f16 v[166:181], v[230:233], v[202:205], v[166:181]
  v_pk_mul_f16 v210, v33, v25 op_sel:[0,0] op_sel_hi:[0,1]
  v_pk_mul_f16 v211, v33, v26 op_sel:[0,0] op_sel_hi:[0,1]
  v_pk_mul_f16 v212, v21, v21 op_sel:[0,0] op_sel_hi:[0,1]
  v_mfma_f32_32x32x16_f16 v[150:165], v[226:229], v[202:205], v[150:165]
  v_pk_mul_f16 v213, v23, v23 op_sel:[0,0] op_sel_hi:[0,1]
  ds_read_b128 v[226:229], v7 offset:21488
  s_waitcnt lgkmcnt(2)
  v_mfma_f32_32x32x16_f16 v[118:133], v[214:217], v[206:209], v[118:133]
  v_pk_mul_f16 v198, v12, v12 op_sel:[0,0] op_sel_hi:[0,1]
  v_pk_mul_f16 v199, v14, v14 op_sel:[0,0] op_sel_hi:[0,1]
  v_mfma_f32_32x32x16_f16 v[134:149], v[218:221], v[206:209], v[134:149]
  v_pk_mul_f16 v200, v16, v16 op_sel:[0,0] op_sel_hi:[0,1]
  v_pk_mul_f16 v201, v18, v18 op_sel:[0,0] op_sel_hi:[0,1]
  ds_read_b128 v[230:233], v7 offset:336
  v_mfma_f32_32x32x16_f16 v[166:181], v[218:221], v[210:213], v[166:181]
  v_pk_mul_f16 v202, v25, v25 op_sel:[0,0] op_sel_hi:[0,1]
  v_pk_mul_f16 v203, v27, v27 op_sel:[0,0] op_sel_hi:[0,1]
  v_pk_mul_f16 v204, v29, v29 op_sel:[0,0] op_sel_hi:[0,1]
  v_mfma_f32_32x32x16_f16 v[150:165], v[214:217], v[210:213], v[150:165]
  v_pk_mul_f16 v205, v31, v31 op_sel:[0,0] op_sel_hi:[0,1]
  ds_read_b128 v[214:217], v7 offset:21504
  s_waitcnt lgkmcnt(2)
  v_mfma_f32_32x32x16_f16 v[118:133], v[222:225], v[198:201], v[118:133]
  v_pk_mul_f16 v206, v20, v20 op_sel:[0,0] op_sel_hi:[0,1]
  v_perm_b32 v207, v11, v9, s12
  v_pk_mul_f16 v207, v207, v207
  v_perm_b32 v208, v15, v13, s12
  v_mfma_f32_32x32x16_f16 v[134:149], v[226:229], v[198:201], v[134:149]
  v_pk_mul_f16 v208, v208, v208
  v_perm_b32 v209, v19, v17, s12
  v_pk_mul_f16 v209, v209, v209
  v_pk_mul_f16 v210, v33, v33 op_sel:[0,0] op_sel_hi:[0,1]
  v_mfma_f32_32x32x16_f16 v[166:181], v[226:229], v[202:205], v[166:181]
  v_perm_b32 v211, v24, v22, s12
  v_pk_mul_f16 v211, v211, v211
  v_perm_b32 v212, v28, v26, s12
  v_pk_mul_f16 v212, v212, v212
  v_mfma_f32_32x32x16_f16 v[150:165], v[222:225], v[202:205], v[150:165]
  v_perm_b32 v213, v32, v30, s12
  v_pk_mul_f16 v213, v213, v213
  s_waitcnt lgkmcnt(0)
  v_mfma_f32_32x32x16_f16 v[118:133], v[230:233], v[206:209], v[118:133]
  v_pk_mul_f16 v198, v40, v195
  v_pk_mul_f16 v199, v44, v195
  v_mfma_f32_32x32x16_f16 v[134:149], v[214:217], v[206:209], v[134:149]
  v_pk_mul_f16 v200, v48, v195
  v_pk_mul_f16 v201, v52, v195
  v_mfma_f32_32x32x16_f16 v[150:165], v[230:233], v[210:213], v[150:165]
  v_pk_mul_f16 v202, v41, v195
  v_pk_mul_f16 v203, v45, v195
  v_pk_mul_f16 v204, v49, v195
  v_mfma_f32_32x32x16_f16 v[166:181], v[214:217], v[210:213], v[166:181]
  v_pk_mul_f16 v205, v53, v195
  v_mfma_f32_32x32x16_f16 v[8:23], v[234:237], v[198:201], 0
  v_pk_mul_f16 v206, v56, v195
  v_pk_mul_f16 v207, v60, v195
  v_pk_mul_f16 v208, v64, v195
  v_mov_b32 v209, v196
  v_fmac_f32 v182, v118, v134
  v_fmac_f32 v183, v119, v135
  v_mfma_f32_32x32x16_f16 v[24:39], v[234:237], v[202:205], 0
  v_pk_mul_f16 v210, v57, v195
  v_pk_mul_f16 v211, v61, v195
  v_pk_mul_f16 v212, v65, v195
  v_mov_b32 v213, v196
  v_fmac_f32 v184, v120, v136
  v_fmac_f32 v185, v121, v137
  v_mfma_f32_32x32x16_f16 v[8:23], v[238:241], v[206:209], v[8:23]
  v_pk_mul_f16 v198, v40, v42 op_sel:[0,0] op_sel_hi:[0,1]
  v_pk_mul_f16 v199, v40, v44 op_sel:[0,0] op_sel_hi:[0,1]
  v_pk_mul_f16 v200, v40, v46 op_sel:[0,0] op_sel_hi:[0,1]
  v_pk_mul_f16 v201, v40, v48 op_sel:[0,0] op_sel_hi:[0,1]
  v_fmac_f32 v186, v122, v138
  v_fmac_f32 v187, v123, v139
  v_mfma_f32_32x32x16_f16 v[24:39], v[238:241], v[210:213], v[24:39]
  v_pk_mul_f16 v202, v41, v43 op_sel:[0,0] op_sel_hi:[0,1]
  v_pk_mul_f16 v203, v41, v45 op_sel:[0,0] op_sel_hi:[0,1]
  v_pk_mul_f16 v204, v41, v47 op_sel:[0,0] op_sel_hi:[0,1]
  v_pk_mul_f16 v205, v41, v49 op_sel:[0,0] op_sel_hi:[0,1]
  v_fmac_f32 v188, v124, v140
  v_fmac_f32 v189, v125, v141
  ds_read_b128 v[218:221], v7 offset:21184
  v_mfma_f32_32x32x16_f16 v[8:23], v[246:249], v[198:201], v[8:23]
  v_pk_mul_f16 v206, v40, v50 op_sel:[0,0] op_sel_hi:[0,1]
  v_pk_mul_f16 v207, v40, v52 op_sel:[0,0] op_sel_hi:[0,1]
  v_fmac_f32 v190, v126, v142
  v_fmac_f32 v191, v127, v143
  v_fmac_f32 v192, v128, v144
  v_mfma_f32_32x32x16_f16 v[24:39], v[246:249], v[202:205], v[24:39]
  v_pk_mul_f16 v208, v42, v44 op_sel:[0,0] op_sel_hi:[0,1]
  v_pk_mul_f16 v209, v42, v46 op_sel:[0,0] op_sel_hi:[0,1]
  v_fmac_f32 v193, v129, v145
  v_fmac_f32 v194, v130, v146
  ds_read_b128 v[222:225], v7 offset:32
  v_mfma_f32_32x32x16_f16 v[134:149], v[242:245], v[202:205], 0
  v_pk_mul_f16 v210, v41, v51 op_sel:[0,0] op_sel_hi:[0,1]
  v_pk_mul_f16 v211, v41, v53 op_sel:[0,0] op_sel_hi:[0,1]
  v_pk_mul_f16 v212, v43, v45 op_sel:[0,0] op_sel_hi:[0,1]
  v_fmac_f32 v182, v150, v166
  v_fmac_f32 v183, v151, v167
  v_mfma_f32_32x32x16_f16 v[118:133], v[242:245], v[198:201], 0
  v_pk_mul_f16 v213, v43, v47 op_sel:[0,0] op_sel_hi:[0,1]
  v_fmac_f32 v184, v152, v168
  v_fmac_f32 v185, v153, v169
  ds_read_b128 v[226:229], v7 offset:21200
  s_waitcnt lgkmcnt(2)
  v_mfma_f32_32x32x16_f16 v[118:133], v[250:253], v[206:209], v[118:133]
  v_pk_mul_f16 v198, v42, v48 op_sel:[0,0] op_sel_hi:[0,1]
  v_pk_mul_f16 v199, v42, v50 op_sel:[0,0] op_sel_hi:[0,1]
  v_fmac_f32 v186, v154, v170
  v_fmac_f32 v187, v155, v171
  v_mfma_f32_32x32x16_f16 v[8:23], v[218:221], v[206:209], v[8:23]
  v_pk_mul_f16 v200, v42, v52 op_sel:[0,0] op_sel_hi:[0,1]
  v_pk_mul_f16 v201, v42, v54 op_sel:[0,0] op_sel_hi:[0,1]
  v_fmac_f32 v188, v156, v172
  v_fmac_f32 v189, v157, v173
  ds_read_b128 v[230:233], v7 offset:48
  v_mfma_f32_32x32x16_f16 v[24:39], v[218:221], v[210:213], v[24:39]
  v_pk_mul_f16 v202, v43, v49 op_sel:[0,0] op_sel_hi:[0,1]
  v_pk_mul_f16 v203, v43, v51 op_sel:[0,0] op_sel_hi:[0,1]
  v_pk_mul_f16 v204, v43, v53 op_sel:[0,0] op_sel_hi:[0,1]
  v_fmac_f32 v190, v158, v174
  v_fmac_f32 v191, v159, v175
  v_mfma_f32_32x32x16_f16 v[134:149], v[250:253], v[210:213], v[134:149]
  v_pk_mul_f16 v205, v43, v55 op_sel:[0,0] op_sel_hi:[0,1]
  v_fmac_f32 v192, v160, v176
  v_fmac_f32 v193, v161, v177
  ds_read_b128 v[214:217], v7 offset:21216
  s_waitcnt lgkmcnt(2)
  v_mfma_f32_32x32x16_f16 v[118:133], v[222:225], v[198:201], v[118:133]
  v_pk_mul_f16 v206, v44, v46 op_sel:[0,0] op_sel_hi:[0,1]
  v_pk_mul_f16 v207, v44, v48 op_sel:[0,0] op_sel_hi:[0,1]
  v_fmac_f32 v194, v162, v178
  v_mfma_f32_32x32x16_f16 v[8:23], v[226:229], v[198:201], v[8:23]
  v_pk_mul_f16 v208, v44, v50 op_sel:[0,0] op_sel_hi:[0,1]
  v_pk_mul_f16 v209, v44, v52 op_sel:[0,0] op_sel_hi:[0,1]
  ds_read_b128 v[218:221], v7 offset:64
  v_mfma_f32_32x32x16_f16 v[24:39], v[226:229], v[202:205], v[24:39]
  v_pk_mul_f16 v210, v45, v47 op_sel:[0,0] op_sel_hi:[0,1]
  v_pk_mul_f16 v211, v45, v49 op_sel:[0,0] op_sel_hi:[0,1]
  v_pk_mul_f16 v212, v45, v51 op_sel:[0,0] op_sel_hi:[0,1]
  v_mfma_f32_32x32x16_f16 v[134:149], v[222:225], v[202:205], v[134:149]
  v_pk_mul_f16 v213, v45, v53 op_sel:[0,0] op_sel_hi:[0,1]
  ds_read_b128 v[222:225], v7 offset:21232
  s_waitcnt lgkmcnt(2)
  v_mfma_f32_32x32x16_f16 v[118:133], v[230:233], v[206:209], v[118:133]
  v_pk_mul_f16 v198, v44, v54 op_sel:[0,0] op_sel_hi:[0,1]
  v_pk_mul_f16 v199, v44, v56 op_sel:[0,0] op_sel_hi:[0,1]
  v_mfma_f32_32x32x16_f16 v[8:23], v[214:217], v[206:209], v[8:23]
  v_pk_mul_f16 v200, v46, v48 op_sel:[0,0] op_sel_hi:[0,1]
  v_pk_mul_f16 v201, v46, v50 op_sel:[0,0] op_sel_hi:[0,1]
  ds_read_b128 v[226:229], v7 offset:80
  v_mfma_f32_32x32x16_f16 v[24:39], v[214:217], v[210:213], v[24:39]
  v_pk_mul_f16 v202, v45, v55 op_sel:[0,0] op_sel_hi:[0,1]
  v_pk_mul_f16 v203, v45, v57 op_sel:[0,0] op_sel_hi:[0,1]
  v_pk_mul_f16 v204, v47, v49 op_sel:[0,0] op_sel_hi:[0,1]
  v_mfma_f32_32x32x16_f16 v[134:149], v[230:233], v[210:213], v[134:149]
  v_pk_mul_f16 v205, v47, v51 op_sel:[0,0] op_sel_hi:[0,1]
  ds_read_b128 v[230:233], v7 offset:21248
  s_waitcnt lgkmcnt(2)
  v_mfma_f32_32x32x16_f16 v[118:133], v[218:221], v[198:201], v[118:133]
  v_pk_mul_f16 v206, v46, v52 op_sel:[0,0] op_sel_hi:[0,1]
  v_pk_mul_f16 v207, v46, v54 op_sel:[0,0] op_sel_hi:[0,1]
  v_mfma_f32_32x32x16_f16 v[8:23], v[222:225], v[198:201], v[8:23]
  v_pk_mul_f16 v208, v46, v56 op_sel:[0,0] op_sel_hi:[0,1]
  v_pk_mul_f16 v209, v46, v58 op_sel:[0,0] op_sel_hi:[0,1]
  ds_read_b128 v[214:217], v7 offset:96
  v_mfma_f32_32x32x16_f16 v[24:39], v[222:225], v[202:205], v[24:39]
  v_pk_mul_f16 v210, v47, v53 op_sel:[0,0] op_sel_hi:[0,1]
  v_pk_mul_f16 v211, v47, v55 op_sel:[0,0] op_sel_hi:[0,1]
  v_pk_mul_f16 v212, v47, v57 op_sel:[0,0] op_sel_hi:[0,1]
  v_mfma_f32_32x32x16_f16 v[134:149], v[218:221], v[202:205], v[134:149]
  v_pk_mul_f16 v213, v47, v59 op_sel:[0,0] op_sel_hi:[0,1]
  ds_read_b128 v[218:221], v7 offset:21264
  s_waitcnt lgkmcnt(2)
  v_mfma_f32_32x32x16_f16 v[118:133], v[226:229], v[206:209], v[118:133]
  v_pk_mul_f16 v198, v48, v50 op_sel:[0,0] op_sel_hi:[0,1]
  v_pk_mul_f16 v199, v48, v52 op_sel:[0,0] op_sel_hi:[0,1]
  v_mfma_f32_32x32x16_f16 v[8:23], v[230:233], v[206:209], v[8:23]
  v_pk_mul_f16 v200, v48, v54 op_sel:[0,0] op_sel_hi:[0,1]
  v_pk_mul_f16 v201, v48, v56 op_sel:[0,0] op_sel_hi:[0,1]
  ds_read_b128 v[222:225], v7 offset:112
  v_mfma_f32_32x32x16_f16 v[24:39], v[230:233], v[210:213], v[24:39]
  v_pk_mul_f16 v202, v49, v51 op_sel:[0,0] op_sel_hi:[0,1]
  v_pk_mul_f16 v203, v49, v53 op_sel:[0,0] op_sel_hi:[0,1]
  v_pk_mul_f16 v204, v49, v55 op_sel:[0,0] op_sel_hi:[0,1]
  v_mfma_f32_32x32x16_f16 v[134:149], v[226:229], v[210:213], v[134:149]
  v_pk_mul_f16 v205, v49, v57 op_sel:[0,0] op_sel_hi:[0,1]
  ds_read_b128 v[226:229], v7 offset:21280
  s_waitcnt lgkmcnt(2)
  v_mfma_f32_32x32x16_f16 v[118:133], v[214:217], v[198:201], v[118:133]
  v_pk_mul_f16 v206, v48, v58 op_sel:[0,0] op_sel_hi:[0,1]
  v_pk_mul_f16 v207, v48, v60 op_sel:[0,0] op_sel_hi:[0,1]
  v_mfma_f32_32x32x16_f16 v[8:23], v[218:221], v[198:201], v[8:23]
  v_pk_mul_f16 v208, v50, v52 op_sel:[0,0] op_sel_hi:[0,1]
  v_pk_mul_f16 v209, v50, v54 op_sel:[0,0] op_sel_hi:[0,1]
  ds_read_b128 v[230:233], v7 offset:128
  v_mfma_f32_32x32x16_f16 v[24:39], v[218:221], v[202:205], v[24:39]
  v_pk_mul_f16 v210, v49, v59 op_sel:[0,0] op_sel_hi:[0,1]
  v_pk_mul_f16 v211, v49, v61 op_sel:[0,0] op_sel_hi:[0,1]
  v_pk_mul_f16 v212, v51, v53 op_sel:[0,0] op_sel_hi:[0,1]
  v_mfma_f32_32x32x16_f16 v[134:149], v[214:217], v[202:205], v[134:149]
  v_pk_mul_f16 v213, v51, v55 op_sel:[0,0] op_sel_hi:[0,1]
  ds_read_b128 v[214:217], v7 offset:21296
  s_waitcnt lgkmcnt(2)
  v_mfma_f32_32x32x16_f16 v[118:133], v[222:225], v[206:209], v[118:133]
  v_pk_mul_f16 v198, v50, v56 op_sel:[0,0] op_sel_hi:[0,1]
  v_pk_mul_f16 v199, v50, v58 op_sel:[0,0] op_sel_hi:[0,1]
  v_mfma_f32_32x32x16_f16 v[8:23], v[226:229], v[206:209], v[8:23]
  v_pk_mul_f16 v200, v50, v60 op_sel:[0,0] op_sel_hi:[0,1]
  v_pk_mul_f16 v201, v50, v62 op_sel:[0,0] op_sel_hi:[0,1]
  ds_read_b128 v[218:221], v7 offset:144
  v_mfma_f32_32x32x16_f16 v[24:39], v[226:229], v[210:213], v[24:39]
  v_pk_mul_f16 v202, v51, v57 op_sel:[0,0] op_sel_hi:[0,1]
  v_pk_mul_f16 v203, v51, v59 op_sel:[0,0] op_sel_hi:[0,1]
  v_pk_mul_f16 v204, v51, v61 op_sel:[0,0] op_sel_hi:[0,1]
  v_mfma_f32_32x32x16_f16 v[134:149], v[222:225], v[210:213], v[134:149]
  v_pk_mul_f16 v205, v51, v63 op_sel:[0,0] op_sel_hi:[0,1]
  ds_read_b128 v[222:225], v7 offset:21312
  s_waitcnt lgkmcnt(2)
  v_mfma_f32_32x32x16_f16 v[118:133], v[230:233], v[198:201], v[118:133]
  v_pk_mul_f16 v206, v52, v54 op_sel:[0,0] op_sel_hi:[0,1]
  v_pk_mul_f16 v207, v52, v56 op_sel:[0,0] op_sel_hi:[0,1]
  v_mfma_f32_32x32x16_f16 v[8:23], v[214:217], v[198:201], v[8:23]
  v_pk_mul_f16 v208, v52, v58 op_sel:[0,0] op_sel_hi:[0,1]
  v_pk_mul_f16 v209, v52, v60 op_sel:[0,0] op_sel_hi:[0,1]
  ds_read_b128 v[226:229], v7 offset:160
  v_mfma_f32_32x32x16_f16 v[24:39], v[214:217], v[202:205], v[24:39]
  v_pk_mul_f16 v210, v53, v55 op_sel:[0,0] op_sel_hi:[0,1]
  v_pk_mul_f16 v211, v53, v57 op_sel:[0,0] op_sel_hi:[0,1]
  v_pk_mul_f16 v212, v53, v59 op_sel:[0,0] op_sel_hi:[0,1]
  v_mfma_f32_32x32x16_f16 v[134:149], v[230:233], v[202:205], v[134:149]
  v_pk_mul_f16 v213, v53, v61 op_sel:[0,0] op_sel_hi:[0,1]
  ds_read_b128 v[230:233], v7 offset:21328
  s_waitcnt lgkmcnt(2)
  v_mfma_f32_32x32x16_f16 v[118:133], v[218:221], v[206:209], v[118:133]
  v_pk_mul_f16 v198, v52, v62 op_sel:[0,0] op_sel_hi:[0,1]
  v_pk_mul_f16 v199, v52, v64 op_sel:[0,0] op_sel_hi:[0,1]
  v_mfma_f32_32x32x16_f16 v[8:23], v[222:225], v[206:209], v[8:23]
  v_pk_mul_f16 v200, v54, v56 op_sel:[0,0] op_sel_hi:[0,1]
  v_pk_mul_f16 v201, v54, v58 op_sel:[0,0] op_sel_hi:[0,1]
  ds_read_b128 v[214:217], v7 offset:176
  v_mfma_f32_32x32x16_f16 v[24:39], v[222:225], v[210:213], v[24:39]
  v_pk_mul_f16 v202, v53, v63 op_sel:[0,0] op_sel_hi:[0,1]
  v_pk_mul_f16 v203, v53, v65 op_sel:[0,0] op_sel_hi:[0,1]
  v_pk_mul_f16 v204, v55, v57 op_sel:[0,0] op_sel_hi:[0,1]
  v_mfma_f32_32x32x16_f16 v[134:149], v[218:221], v[210:213], v[134:149]
  v_pk_mul_f16 v205, v55, v59 op_sel:[0,0] op_sel_hi:[0,1]
  ds_read_b128 v[218:221], v7 offset:21344
  s_waitcnt lgkmcnt(2)
  v_mfma_f32_32x32x16_f16 v[118:133], v[226:229], v[198:201], v[118:133]
  v_pk_mul_f16 v206, v54, v60 op_sel:[0,0] op_sel_hi:[0,1]
  v_pk_mul_f16 v207, v54, v62 op_sel:[0,0] op_sel_hi:[0,1]
  v_mfma_f32_32x32x16_f16 v[8:23], v[230:233], v[198:201], v[8:23]
  v_pk_mul_f16 v208, v54, v64 op_sel:[0,0] op_sel_hi:[0,1]
  v_pk_mul_f16 v209, v54, v40 op_sel:[0,0] op_sel_hi:[0,1]
  ds_read_b128 v[222:225], v7 offset:192
  v_mfma_f32_32x32x16_f16 v[24:39], v[230:233], v[202:205], v[24:39]
  v_pk_mul_f16 v210, v55, v61 op_sel:[0,0] op_sel_hi:[0,1]
  v_pk_mul_f16 v211, v55, v63 op_sel:[0,0] op_sel_hi:[0,1]
  v_pk_mul_f16 v212, v55, v65 op_sel:[0,0] op_sel_hi:[0,1]
  v_mfma_f32_32x32x16_f16 v[134:149], v[226:229], v[202:205], v[134:149]
  v_pk_mul_f16 v213, v55, v41 op_sel:[0,0] op_sel_hi:[0,1]
  ds_read_b128 v[226:229], v7 offset:21360
  s_waitcnt lgkmcnt(2)
  v_mfma_f32_32x32x16_f16 v[118:133], v[214:217], v[206:209], v[118:133]
  v_pk_mul_f16 v198, v56, v58 op_sel:[0,0] op_sel_hi:[0,1]
  v_pk_mul_f16 v199, v56, v60 op_sel:[0,0] op_sel_hi:[0,1]
  v_mfma_f32_32x32x16_f16 v[8:23], v[218:221], v[206:209], v[8:23]
  v_pk_mul_f16 v200, v56, v62 op_sel:[0,0] op_sel_hi:[0,1]
  v_pk_mul_f16 v201, v56, v64 op_sel:[0,0] op_sel_hi:[0,1]
  ds_read_b128 v[230:233], v7 offset:208
  v_mfma_f32_32x32x16_f16 v[24:39], v[218:221], v[210:213], v[24:39]
  v_pk_mul_f16 v202, v57, v59 op_sel:[0,0] op_sel_hi:[0,1]
  v_pk_mul_f16 v203, v57, v61 op_sel:[0,0] op_sel_hi:[0,1]
  v_pk_mul_f16 v204, v57, v63 op_sel:[0,0] op_sel_hi:[0,1]
  v_mfma_f32_32x32x16_f16 v[134:149], v[214:217], v[210:213], v[134:149]
  v_pk_mul_f16 v205, v57, v65 op_sel:[0,0] op_sel_hi:[0,1]
  ds_read_b128 v[214:217], v7 offset:21376
  s_waitcnt lgkmcnt(2)
  v_mfma_f32_32x32x16_f16 v[118:133], v[222:225], v[198:201], v[118:133]
  v_pk_mul_f16 v206, v56, v40 op_sel:[0,0] op_sel_hi:[0,1]
  v_pk_mul_f16 v207, v56, v42 op_sel:[0,0] op_sel_hi:[0,1]
  v_mfma_f32_32x32x16_f16 v[8:23], v[226:229], v[198:201], v[8:23]
  v_pk_mul_f16 v208, v58, v60 op_sel:[0,0] op_sel_hi:[0,1]
  v_pk_mul_f16 v209, v58, v62 op_sel:[0,0] op_sel_hi:[0,1]
  ds_read_b128 v[218:221], v7 offset:224
  v_mfma_f32_32x32x16_f16 v[24:39], v[226:229], v[202:205], v[24:39]
  v_pk_mul_f16 v210, v57, v41 op_sel:[0,0] op_sel_hi:[0,1]
  v_pk_mul_f16 v211, v57, v43 op_sel:[0,0] op_sel_hi:[0,1]
  v_pk_mul_f16 v212, v59, v61 op_sel:[0,0] op_sel_hi:[0,1]
  v_mfma_f32_32x32x16_f16 v[134:149], v[222:225], v[202:205], v[134:149]
  v_pk_mul_f16 v213, v59, v63 op_sel:[0,0] op_sel_hi:[0,1]
  ds_read_b128 v[222:225], v7 offset:21392
  s_waitcnt lgkmcnt(2)
  v_mfma_f32_32x32x16_f16 v[118:133], v[230:233], v[206:209], v[118:133]
  v_pk_mul_f16 v198, v58, v64 op_sel:[0,0] op_sel_hi:[0,1]
  v_pk_mul_f16 v199, v58, v40 op_sel:[0,0] op_sel_hi:[0,1]
  v_mfma_f32_32x32x16_f16 v[8:23], v[214:217], v[206:209], v[8:23]
  v_pk_mul_f16 v200, v58, v42 op_sel:[0,0] op_sel_hi:[0,1]
  v_pk_mul_f16 v201, v58, v44 op_sel:[0,0] op_sel_hi:[0,1]
  ds_read_b128 v[226:229], v7 offset:240
  v_mfma_f32_32x32x16_f16 v[24:39], v[214:217], v[210:213], v[24:39]
  v_pk_mul_f16 v202, v59, v65 op_sel:[0,0] op_sel_hi:[0,1]
  v_pk_mul_f16 v203, v59, v41 op_sel:[0,0] op_sel_hi:[0,1]
  v_pk_mul_f16 v204, v59, v43 op_sel:[0,0] op_sel_hi:[0,1]
  v_mfma_f32_32x32x16_f16 v[134:149], v[230:233], v[210:213], v[134:149]
  v_pk_mul_f16 v205, v59, v45 op_sel:[0,0] op_sel_hi:[0,1]
  ds_read_b128 v[230:233], v7 offset:21408
  s_waitcnt lgkmcnt(2)
  v_mfma_f32_32x32x16_f16 v[118:133], v[218:221], v[198:201], v[118:133]
  v_pk_mul_f16 v206, v60, v62 op_sel:[0,0] op_sel_hi:[0,1]
  v_pk_mul_f16 v207, v60, v64 op_sel:[0,0] op_sel_hi:[0,1]
  v_mfma_f32_32x32x16_f16 v[8:23], v[222:225], v[198:201], v[8:23]
  v_pk_mul_f16 v208, v60, v40 op_sel:[0,0] op_sel_hi:[0,1]
  v_pk_mul_f16 v209, v60, v42 op_sel:[0,0] op_sel_hi:[0,1]
  ds_read_b128 v[214:217], v7 offset:256
  v_mfma_f32_32x32x16_f16 v[24:39], v[222:225], v[202:205], v[24:39]
  v_pk_mul_f16 v210, v61, v63 op_sel:[0,0] op_sel_hi:[0,1]
  v_pk_mul_f16 v211, v61, v65 op_sel:[0,0] op_sel_hi:[0,1]
  v_pk_mul_f16 v212, v61, v41 op_sel:[0,0] op_sel_hi:[0,1]
  v_mfma_f32_32x32x16_f16 v[134:149], v[218:221], v[202:205], v[134:149]
  v_pk_mul_f16 v213, v61, v43 op_sel:[0,0] op_sel_hi:[0,1]
  ds_read_b128 v[218:221], v7 offset:21424
  s_waitcnt lgkmcnt(2)
  v_mfma_f32_32x32x16_f16 v[118:133], v[226:229], v[206:209], v[118:133]
  v_pk_mul_f16 v198, v60, v44 op_sel:[0,0] op_sel_hi:[0,1]
  v_pk_mul_f16 v199, v60, v46 op_sel:[0,0] op_sel_hi:[0,1]
  v_mfma_f32_32x32x16_f16 v[8:23], v[230:233], v[206:209], v[8:23]
  v_pk_mul_f16 v200, v62, v64 op_sel:[0,0] op_sel_hi:[0,1]
  v_pk_mul_f16 v201, v62, v40 op_sel:[0,0] op_sel_hi:[0,1]
  ds_read_b128 v[222:225], v7 offset:272
  v_mfma_f32_32x32x16_f16 v[24:39], v[230:233], v[210:213], v[24:39]
  v_pk_mul_f16 v202, v61, v45 op_sel:[0,0] op_sel_hi:[0,1]
  v_pk_mul_f16 v203, v61, v47 op_sel:[0,0] op_sel_hi:[0,1]
  v_pk_mul_f16 v204, v63, v65 op_sel:[0,0] op_sel_hi:[0,1]
  v_mfma_f32_32x32x16_f16 v[134:149], v[226:229], v[210:213], v[134:149]
  v_pk_mul_f16 v205, v63, v41 op_sel:[0,0] op_sel_hi:[0,1]
  ds_read_b128 v[226:229], v7 offset:21440
  s_waitcnt lgkmcnt(2)
  v_mfma_f32_32x32x16_f16 v[118:133], v[214:217], v[198:201], v[118:133]
  v_pk_mul_f16 v206, v62, v42 op_sel:[0,0] op_sel_hi:[0,1]
  v_pk_mul_f16 v207, v62, v44 op_sel:[0,0] op_sel_hi:[0,1]
  v_mfma_f32_32x32x16_f16 v[8:23], v[218:221], v[198:201], v[8:23]
  v_pk_mul_f16 v208, v62, v46 op_sel:[0,0] op_sel_hi:[0,1]
  v_pk_mul_f16 v209, v62, v48 op_sel:[0,0] op_sel_hi:[0,1]
  ds_read_b128 v[230:233], v7 offset:288
  v_mfma_f32_32x32x16_f16 v[24:39], v[218:221], v[202:205], v[24:39]
  v_pk_mul_f16 v210, v63, v43 op_sel:[0,0] op_sel_hi:[0,1]
  v_pk_mul_f16 v211, v63, v45 op_sel:[0,0] op_sel_hi:[0,1]
  v_pk_mul_f16 v212, v63, v47 op_sel:[0,0] op_sel_hi:[0,1]
  v_mfma_f32_32x32x16_f16 v[134:149], v[214:217], v[202:205], v[134:149]
  v_pk_mul_f16 v213, v63, v49 op_sel:[0,0] op_sel_hi:[0,1]
  ds_read_b128 v[214:217], v7 offset:21456
  s_waitcnt lgkmcnt(2)
  v_mfma_f32_32x32x16_f16 v[118:133], v[222:225], v[206:209], v[118:133]
  v_pk_mul_f16 v198, v64, v40 op_sel:[0,0] op_sel_hi:[0,1]
  v_pk_mul_f16 v199, v64, v42 op_sel:[0,0] op_sel_hi:[0,1]
  v_mfma_f32_32x32x16_f16 v[8:23], v[226:229], v[206:209], v[8:23]
  v_pk_mul_f16 v200, v64, v44 op_sel:[0,0] op_sel_hi:[0,1]
  v_pk_mul_f16 v201, v64, v46 op_sel:[0,0] op_sel_hi:[0,1]
  ds_read_b128 v[218:221], v7 offset:304
  v_mfma_f32_32x32x16_f16 v[24:39], v[226:229], v[210:213], v[24:39]
  v_pk_mul_f16 v202, v65, v41 op_sel:[0,0] op_sel_hi:[0,1]
  v_pk_mul_f16 v203, v65, v43 op_sel:[0,0] op_sel_hi:[0,1]
  v_pk_mul_f16 v204, v65, v45 op_sel:[0,0] op_sel_hi:[0,1]
  v_mfma_f32_32x32x16_f16 v[134:149], v[222:225], v[210:213], v[134:149]
  v_pk_mul_f16 v205, v65, v47 op_sel:[0,0] op_sel_hi:[0,1]
  ds_read_b128 v[222:225], v7 offset:21472
  s_waitcnt lgkmcnt(2)
  v_mfma_f32_32x32x16_f16 v[118:133], v[230:233], v[198:201], v[118:133]
  v_pk_mul_f16 v206, v64, v48 op_sel:[0,0] op_sel_hi:[0,1]
  v_pk_mul_f16 v207, v64, v50 op_sel:[0,0] op_sel_hi:[0,1]
  v_mfma_f32_32x32x16_f16 v[8:23], v[214:217], v[198:201], v[8:23]
  v_pk_mul_f16 v208, v40, v40 op_sel:[0,0] op_sel_hi:[0,1]
  v_pk_mul_f16 v209, v44, v44 op_sel:[0,0] op_sel_hi:[0,1]
  ds_read_b128 v[226:229], v7 offset:320
  v_mfma_f32_32x32x16_f16 v[24:39], v[214:217], v[202:205], v[24:39]
  v_pk_mul_f16 v210, v65, v49 op_sel:[0,0] op_sel_hi:[0,1]
  v_pk_mul_f16 v211, v65, v51 op_sel:[0,0] op_sel_hi:[0,1]
  v_pk_mul_f16 v212, v41, v41 op_sel:[0,0] op_sel_hi:[0,1]
  v_mfma_f32_32x32x16_f16 v[134:149], v[230:233], v[202:205], v[134:149]
  v_pk_mul_f16 v213, v45, v45 op_sel:[0,0] op_sel_hi:[0,1]
  ds_read_b128 v[230:233], v7 offset:21488
  s_waitcnt lgkmcnt(2)
  v_mfma_f32_32x32x16_f16 v[118:133], v[218:221], v[206:209], v[118:133]
  v_pk_mul_f16 v198, v48, v48 op_sel:[0,0] op_sel_hi:[0,1]
  v_pk_mul_f16 v199, v52, v52 op_sel:[0,0] op_sel_hi:[0,1]
  v_mfma_f32_32x32x16_f16 v[8:23], v[222:225], v[206:209], v[8:23]
  v_pk_mul_f16 v200, v56, v56 op_sel:[0,0] op_sel_hi:[0,1]
  v_pk_mul_f16 v201, v60, v60 op_sel:[0,0] op_sel_hi:[0,1]
  ds_read_b128 v[214:217], v7 offset:336
  v_mfma_f32_32x32x16_f16 v[24:39], v[222:225], v[210:213], v[24:39]
  v_pk_mul_f16 v202, v49, v49 op_sel:[0,0] op_sel_hi:[0,1]
  v_pk_mul_f16 v203, v53, v53 op_sel:[0,0] op_sel_hi:[0,1]
  v_pk_mul_f16 v204, v57, v57 op_sel:[0,0] op_sel_hi:[0,1]
  v_mfma_f32_32x32x16_f16 v[134:149], v[218:221], v[210:213], v[134:149]
  v_pk_mul_f16 v205, v61, v61 op_sel:[0,0] op_sel_hi:[0,1]
  ds_read_b128 v[218:221], v7 offset:21504
  s_waitcnt lgkmcnt(2)
  v_mfma_f32_32x32x16_f16 v[118:133], v[226:229], v[198:201], v[118:133]
  v_pk_mul_f16 v206, v64, v64 op_sel:[0,0] op_sel_hi:[0,1]
  v_perm_b32 v207, v46, v42, s12
  v_pk_mul_f16 v207, v207, v207
  v_perm_b32 v208, v54, v50, s12
  v_mfma_f32_32x32x16_f16 v[8:23], v[230:233], v[198:201], v[8:23]
  v_pk_mul_f16 v208, v208, v208
  v_perm_b32 v209, v62, v58, s12
  v_pk_mul_f16 v209, v209, v209
  v_pk_mul_f16 v210, v65, v65 op_sel:[0,0] op_sel_hi:[0,1]
  v_mfma_f32_32x32x16_f16 v[24:39], v[230:233], v[202:205], v[24:39]
  v_perm_b32 v211, v47, v43, s12
  v_pk_mul_f16 v211, v211, v211
  v_perm_b32 v212, v55, v51, s12
  v_pk_mul_f16 v212, v212, v212
  v_mfma_f32_32x32x16_f16 v[134:149], v[226:229], v[202:205], v[134:149]
  v_perm_b32 v213, v63, v59, s12
  v_pk_mul_f16 v213, v213, v213
  s_waitcnt lgkmcnt(0)
  v_mfma_f32_32x32x16_f16 v[118:133], v[214:217], v[206:209], v[118:133]
  v_pk_mul_f16 v198, v66, v195
  v_pk_mul_f16 v199, v70, v195
  v_mfma_f32_32x32x16_f16 v[8:23], v[218:221], v[206:209], v[8:23]
  v_pk_mul_f16 v200, v74, v195
  v_pk_mul_f16 v201, v78, v195
  v_mfma_f32_32x32x16_f16 v[134:149], v[214:217], v[210:213], v[134:149]
  v_pk_mul_f16 v202, v67, v195
  v_pk_mul_f16 v203, v71, v195
  v_pk_mul_f16 v204, v75, v195
  v_mfma_f32_32x32x16_f16 v[24:39], v[218:221], v[210:213], v[24:39]
  v_pk_mul_f16 v205, v79, v195
  v_mfma_f32_32x32x16_f16 v[150:165], v[234:237], v[198:201], 0
  v_pk_mul_f16 v206, v82, v195
  v_pk_mul_f16 v207, v86, v195
  v_pk_mul_f16 v208, v90, v195
  v_mov_b32 v209, v196
  v_fmac_f32 v182, v118, v8
  v_fmac_f32 v183, v119, v9
  v_mfma_f32_32x32x16_f16 v[166:181], v[234:237], v[202:205], 0
  v_pk_mul_f16 v210, v83, v195
  v_pk_mul_f16 v211, v87, v195
  v_pk_mul_f16 v212, v91, v195
  v_mov_b32 v213, v196
  v_fmac_f32 v184, v120, v10
  v_fmac_f32 v185, v121, v11
  v_mfma_f32_32x32x16_f16 v[150:165], v[238:241], v[206:209], v[150:165]
  v_pk_mul_f16 v198, v66, v68 op_sel:[0,0] op_sel_hi:[0,1]
  v_pk_mul_f16 v199, v66, v70 op_sel:[0,0] op_sel_hi:[0,1]
  v_pk_mul_f16 v200, v66, v72 op_sel:[0,0] op_sel_hi:[0,1]
  v_pk_mul_f16 v201, v66, v74 op_sel:[0,0] op_sel_hi:[0,1]
  v_fmac_f32 v186, v122, v12
  v_fmac_f32 v187, v123, v13
  v_mfma_f32_32x32x16_f16 v[166:181], v[238:241], v[210:213], v[166:181]
  v_pk_mul_f16 v202, v67, v69 op_sel:[0,0] op_sel_hi:[0,1]
  v_pk_mul_f16 v203, v67, v71 op_sel:[0,0] op_sel_hi:[0,1]
  v_pk_mul_f16 v204, v67, v73 op_sel:[0,0] op_sel_hi:[0,1]
  v_pk_mul_f16 v205, v67, v75 op_sel:[0,0] op_sel_hi:[0,1]
  v_fmac_f32 v188, v124, v14
  v_fmac_f32 v189, v125, v15
  ds_read_b128 v[40:43], v7 offset:21184
  v_mfma_f32_32x32x16_f16 v[150:165], v[246:249], v[198:201], v[150:165]
  v_pk_mul_f16 v206, v66, v76 op_sel:[0,0] op_sel_hi:[0,1]
  v_pk_mul_f16 v207, v66, v78 op_sel:[0,0] op_sel_hi:[0,1]
  v_fmac_f32 v190, v126, v16
  v_fmac_f32 v191, v127, v17
  v_fmac_f32 v192, v128, v18
  v_mfma_f32_32x32x16_f16 v[166:181], v[246:249], v[202:205], v[166:181]
  v_pk_mul_f16 v208, v68, v70 op_sel:[0,0] op_sel_hi:[0,1]
  v_pk_mul_f16 v209, v68, v72 op_sel:[0,0] op_sel_hi:[0,1]
  v_fmac_f32 v193, v129, v19
  v_fmac_f32 v194, v130, v20
  ds_read_b128 v[44:47], v7 offset:32
  v_mfma_f32_32x32x16_f16 v[8:23], v[242:245], v[202:205], 0
  v_pk_mul_f16 v210, v67, v77 op_sel:[0,0] op_sel_hi:[0,1]
  v_pk_mul_f16 v211, v67, v79 op_sel:[0,0] op_sel_hi:[0,1]
  v_pk_mul_f16 v212, v69, v71 op_sel:[0,0] op_sel_hi:[0,1]
  v_fmac_f32 v182, v134, v24
  v_fmac_f32 v183, v135, v25
  v_mfma_f32_32x32x16_f16 v[118:133], v[242:245], v[198:201], 0
  v_pk_mul_f16 v213, v69, v73 op_sel:[0,0] op_sel_hi:[0,1]
  v_fmac_f32 v184, v136, v26
  v_fmac_f32 v185, v137, v27
  ds_read_b128 v[48:51], v7 offset:21200
  s_waitcnt lgkmcnt(2)
  v_mfma_f32_32x32x16_f16 v[118:133], v[250:253], v[206:209], v[118:133]
  v_pk_mul_f16 v198, v68, v74 op_sel:[0,0] op_sel_hi:[0,1]
  v_pk_mul_f16 v199, v68, v76 op_sel:[0,0] op_sel_hi:[0,1]
  v_fmac_f32 v186, v138, v28
  v_fmac_f32 v187, v139, v29
  v_mfma_f32_32x32x16_f16 v[150:165], v[40:43], v[206:209], v[150:165]
  v_pk_mul_f16 v200, v68, v78 op_sel:[0,0] op_sel_hi:[0,1]
  v_pk_mul_f16 v201, v68, v80 op_sel:[0,0] op_sel_hi:[0,1]
  v_fmac_f32 v188, v140, v30
  v_fmac_f32 v189, v141, v31
  ds_read_b128 v[52:55], v7 offset:48
  v_mfma_f32_32x32x16_f16 v[166:181], v[40:43], v[210:213], v[166:181]
  v_pk_mul_f16 v202, v69, v75 op_sel:[0,0] op_sel_hi:[0,1]
  v_pk_mul_f16 v203, v69, v77 op_sel:[0,0] op_sel_hi:[0,1]
  v_pk_mul_f16 v204, v69, v79 op_sel:[0,0] op_sel_hi:[0,1]
  v_fmac_f32 v190, v142, v32
  v_fmac_f32 v191, v143, v33
  v_mfma_f32_32x32x16_f16 v[8:23], v[250:253], v[210:213], v[8:23]
  v_pk_mul_f16 v205, v69, v81 op_sel:[0,0] op_sel_hi:[0,1]
  v_fmac_f32 v192, v144, v34
  v_fmac_f32 v193, v145, v35
  ds_read_b128 v[56:59], v7 offset:21216
  s_waitcnt lgkmcnt(2)
  v_mfma_f32_32x32x16_f16 v[118:133], v[44:47], v[198:201], v[118:133]
  v_pk_mul_f16 v206, v70, v72 op_sel:[0,0] op_sel_hi:[0,1]
  v_pk_mul_f16 v207, v70, v74 op_sel:[0,0] op_sel_hi:[0,1]
  v_fmac_f32 v194, v146, v36
  v_mfma_f32_32x32x16_f16 v[150:165], v[48:51], v[198:201], v[150:165]
  v_pk_mul_f16 v208, v70, v76 op_sel:[0,0] op_sel_hi:[0,1]
  v_pk_mul_f16 v209, v70, v78 op_sel:[0,0] op_sel_hi:[0,1]
  ds_read_b128 v[60:63], v7 offset:64
  v_mfma_f32_32x32x16_f16 v[166:181], v[48:51], v[202:205], v[166:181]
  v_pk_mul_f16 v210, v71, v73 op_sel:[0,0] op_sel_hi:[0,1]
  v_pk_mul_f16 v211, v71, v75 op_sel:[0,0] op_sel_hi:[0,1]
  v_pk_mul_f16 v212, v71, v77 op_sel:[0,0] op_sel_hi:[0,1]
  v_mfma_f32_32x32x16_f16 v[8:23], v[44:47], v[202:205], v[8:23]
  v_pk_mul_f16 v213, v71, v79 op_sel:[0,0] op_sel_hi:[0,1]
  ds_read_b128 v[222:225], v7 offset:21232
  s_waitcnt lgkmcnt(2)
  v_mfma_f32_32x32x16_f16 v[118:133], v[52:55], v[206:209], v[118:133]
  v_pk_mul_f16 v198, v70, v80 op_sel:[0,0] op_sel_hi:[0,1]
  v_pk_mul_f16 v199, v70, v82 op_sel:[0,0] op_sel_hi:[0,1]
  v_mfma_f32_32x32x16_f16 v[150:165], v[56:59], v[206:209], v[150:165]
  v_pk_mul_f16 v200, v72, v74 op_sel:[0,0] op_sel_hi:[0,1]
  v_pk_mul_f16 v201, v72, v76 op_sel:[0,0] op_sel_hi:[0,1]
  ds_read_b128 v[226:229], v7 offset:80
  v_mfma_f32_32x32x16_f16 v[166:181], v[56:59], v[210:213], v[166:181]
  v_pk_mul_f16 v202, v71, v81 op_sel:[0,0] op_sel_hi:[0,1]
  v_pk_mul_f16 v203, v71, v83 op_sel:[0,0] op_sel_hi:[0,1]
  v_pk_mul_f16 v204, v73, v75 op_sel:[0,0] op_sel_hi:[0,1]
  v_mfma_f32_32x32x16_f16 v[8:23], v[52:55], v[210:213], v[8:23]
  v_pk_mul_f16 v205, v73, v77 op_sel:[0,0] op_sel_hi:[0,1]
  ds_read_b128 v[230:233], v7 offset:21248
  s_waitcnt lgkmcnt(2)
  v_mfma_f32_32x32x16_f16 v[118:133], v[60:63], v[198:201], v[118:133]
  v_pk_mul_f16 v206, v72, v78 op_sel:[0,0] op_sel_hi:[0,1]
  v_pk_mul_f16 v207, v72, v80 op_sel:[0,0] op_sel_hi:[0,1]
  v_mfma_f32_32x32x16_f16 v[150:165], v[222:225], v[198:201], v[150:165]
  v_pk_mul_f16 v208, v72, v82 op_sel:[0,0] op_sel_hi:[0,1]
  v_pk_mul_f16 v209, v72, v84 op_sel:[0,0] op_sel_hi:[0,1]
  ds_read_b128 v[214:217], v7 offset:96
  v_mfma_f32_32x32x16_f16 v[166:181], v[222:225], v[202:205], v[166:181]
  v_pk_mul_f16 v210, v73, v79 op_sel:[0,0] op_sel_hi:[0,1]
  v_pk_mul_f16 v211, v73, v81 op_sel:[0,0] op_sel_hi:[0,1]
  v_pk_mul_f16 v212, v73, v83 op_sel:[0,0] op_sel_hi:[0,1]
  v_mfma_f32_32x32x16_f16 v[8:23], v[60:63], v[202:205], v[8:23]
  v_pk_mul_f16 v213, v73, v85 op_sel:[0,0] op_sel_hi:[0,1]
  ds_read_b128 v[218:221], v7 offset:21264
  s_waitcnt lgkmcnt(2)
  v_mfma_f32_32x32x16_f16 v[118:133], v[226:229], v[206:209], v[118:133]
  v_pk_mul_f16 v198, v74, v76 op_sel:[0,0] op_sel_hi:[0,1]
  v_pk_mul_f16 v199, v74, v78 op_sel:[0,0] op_sel_hi:[0,1]
  v_mfma_f32_32x32x16_f16 v[150:165], v[230:233], v[206:209], v[150:165]
  v_pk_mul_f16 v200, v74, v80 op_sel:[0,0] op_sel_hi:[0,1]
  v_pk_mul_f16 v201, v74, v82 op_sel:[0,0] op_sel_hi:[0,1]
  ds_read_b128 v[222:225], v7 offset:112
  v_mfma_f32_32x32x16_f16 v[166:181], v[230:233], v[210:213], v[166:181]
  v_pk_mul_f16 v202, v75, v77 op_sel:[0,0] op_sel_hi:[0,1]
  v_pk_mul_f16 v203, v75, v79 op_sel:[0,0] op_sel_hi:[0,1]
  v_pk_mul_f16 v204, v75, v81 op_sel:[0,0] op_sel_hi:[0,1]
  v_mfma_f32_32x32x16_f16 v[8:23], v[226:229], v[210:213], v[8:23]
  v_pk_mul_f16 v205, v75, v83 op_sel:[0,0] op_sel_hi:[0,1]
  ds_read_b128 v[226:229], v7 offset:21280
  s_waitcnt lgkmcnt(2)
  v_mfma_f32_32x32x16_f16 v[118:133], v[214:217], v[198:201], v[118:133]
  v_pk_mul_f16 v206, v74, v84 op_sel:[0,0] op_sel_hi:[0,1]
  v_pk_mul_f16 v207, v74, v86 op_sel:[0,0] op_sel_hi:[0,1]
  v_mfma_f32_32x32x16_f16 v[150:165], v[218:221], v[198:201], v[150:165]
  v_pk_mul_f16 v208, v76, v78 op_sel:[0,0] op_sel_hi:[0,1]
  v_pk_mul_f16 v209, v76, v80 op_sel:[0,0] op_sel_hi:[0,1]
  ds_read_b128 v[230:233], v7 offset:128
  v_mfma_f32_32x32x16_f16 v[166:181], v[218:221], v[202:205], v[166:181]
  v_pk_mul_f16 v210, v75, v85 op_sel:[0,0] op_sel_hi:[0,1]
  v_pk_mul_f16 v211, v75, v87 op_sel:[0,0] op_sel_hi:[0,1]
  v_pk_mul_f16 v212, v77, v79 op_sel:[0,0] op_sel_hi:[0,1]
  v_mfma_f32_32x32x16_f16 v[8:23], v[214:217], v[202:205], v[8:23]
  v_pk_mul_f16 v213, v77, v81 op_sel:[0,0] op_sel_hi:[0,1]
  ds_read_b128 v[214:217], v7 offset:21296
  s_waitcnt lgkmcnt(2)
  v_mfma_f32_32x32x16_f16 v[118:133], v[222:225], v[206:209], v[118:133]
  v_pk_mul_f16 v198, v76, v82 op_sel:[0,0] op_sel_hi:[0,1]
  v_pk_mul_f16 v199, v76, v84 op_sel:[0,0] op_sel_hi:[0,1]
  v_mfma_f32_32x32x16_f16 v[150:165], v[226:229], v[206:209], v[150:165]
  v_pk_mul_f16 v200, v76, v86 op_sel:[0,0] op_sel_hi:[0,1]
  v_pk_mul_f16 v201, v76, v88 op_sel:[0,0] op_sel_hi:[0,1]
  ds_read_b128 v[218:221], v7 offset:144
  v_mfma_f32_32x32x16_f16 v[166:181], v[226:229], v[210:213], v[166:181]
  v_pk_mul_f16 v202, v77, v83 op_sel:[0,0] op_sel_hi:[0,1]
  v_pk_mul_f16 v203, v77, v85 op_sel:[0,0] op_sel_hi:[0,1]
  v_pk_mul_f16 v204, v77, v87 op_sel:[0,0] op_sel_hi:[0,1]
  v_mfma_f32_32x32x16_f16 v[8:23], v[222:225], v[210:213], v[8:23]
  v_pk_mul_f16 v205, v77, v89 op_sel:[0,0] op_sel_hi:[0,1]
  ds_read_b128 v[222:225], v7 offset:21312
  s_waitcnt lgkmcnt(2)
  v_mfma_f32_32x32x16_f16 v[118:133], v[230:233], v[198:201], v[118:133]
  v_pk_mul_f16 v206, v78, v80 op_sel:[0,0] op_sel_hi:[0,1]
  v_pk_mul_f16 v207, v78, v82 op_sel:[0,0] op_sel_hi:[0,1]
  v_mfma_f32_32x32x16_f16 v[150:165], v[214:217], v[198:201], v[150:165]
  v_pk_mul_f16 v208, v78, v84 op_sel:[0,0] op_sel_hi:[0,1]
  v_pk_mul_f16 v209, v78, v86 op_sel:[0,0] op_sel_hi:[0,1]
  ds_read_b128 v[226:229], v7 offset:160
  v_mfma_f32_32x32x16_f16 v[166:181], v[214:217], v[202:205], v[166:181]
  v_pk_mul_f16 v210, v79, v81 op_sel:[0,0] op_sel_hi:[0,1]
  v_pk_mul_f16 v211, v79, v83 op_sel:[0,0] op_sel_hi:[0,1]
  v_pk_mul_f16 v212, v79, v85 op_sel:[0,0] op_sel_hi:[0,1]
  v_mfma_f32_32x32x16_f16 v[8:23], v[230:233], v[202:205], v[8:23]
  v_pk_mul_f16 v213, v79, v87 op_sel:[0,0] op_sel_hi:[0,1]
  ds_read_b128 v[230:233], v7 offset:21328
  s_waitcnt lgkmcnt(2)
  v_mfma_f32_32x32x16_f16 v[118:133], v[218:221], v[206:209], v[118:133]
  v_pk_mul_f16 v198, v78, v88 op_sel:[0,0] op_sel_hi:[0,1]
  v_pk_mul_f16 v199, v78, v90 op_sel:[0,0] op_sel_hi:[0,1]
  v_mfma_f32_32x32x16_f16 v[150:165], v[222:225], v[206:209], v[150:165]
  v_pk_mul_f16 v200, v80, v82 op_sel:[0,0] op_sel_hi:[0,1]
  v_pk_mul_f16 v201, v80, v84 op_sel:[0,0] op_sel_hi:[0,1]
  ds_read_b128 v[214:217], v7 offset:176
  v_mfma_f32_32x32x16_f16 v[166:181], v[222:225], v[210:213], v[166:181]
  v_pk_mul_f16 v202, v79, v89 op_sel:[0,0] op_sel_hi:[0,1]
  v_pk_mul_f16 v203, v79, v91 op_sel:[0,0] op_sel_hi:[0,1]
  v_pk_mul_f16 v204, v81, v83 op_sel:[0,0] op_sel_hi:[0,1]
  v_mfma_f32_32x32x16_f16 v[8:23], v[218:221], v[210:213], v[8:23]
  v_pk_mul_f16 v205, v81, v85 op_sel:[0,0] op_sel_hi:[0,1]
  ds_read_b128 v[218:221], v7 offset:21344
  s_waitcnt lgkmcnt(2)
  v_mfma_f32_32x32x16_f16 v[118:133], v[226:229], v[198:201], v[118:133]
  v_pk_mul_f16 v206, v80, v86 op_sel:[0,0] op_sel_hi:[0,1]
  v_pk_mul_f16 v207, v80, v88 op_sel:[0,0] op_sel_hi:[0,1]
  v_mfma_f32_32x32x16_f16 v[150:165], v[230:233], v[198:201], v[150:165]
  v_pk_mul_f16 v208, v80, v90 op_sel:[0,0] op_sel_hi:[0,1]
  v_pk_mul_f16 v209, v80, v66 op_sel:[0,0] op_sel_hi:[0,1]
  ds_read_b128 v[222:225], v7 offset:192
  v_mfma_f32_32x32x16_f16 v[166:181], v[230:233], v[202:205], v[166:181]
  v_pk_mul_f16 v210, v81, v87 op_sel:[0,0] op_sel_hi:[0,1]
  v_pk_mul_f16 v211, v81, v89 op_sel:[0,0] op_sel_hi:[0,1]
  v_pk_mul_f16 v212, v81, v91 op_sel:[0,0] op_sel_hi:[0,1]
  v_mfma_f32_32x32x16_f16 v[8:23], v[226:229], v[202:205], v[8:23]
  v_pk_mul_f16 v213, v81, v67 op_sel:[0,0] op_sel_hi:[0,1]
  ds_read_b128 v[226:229], v7 offset:21360
  s_waitcnt lgkmcnt(2)
  v_mfma_f32_32x32x16_f16 v[118:133], v[214:217], v[206:209], v[118:133]
  v_pk_mul_f16 v198, v82, v84 op_sel:[0,0] op_sel_hi:[0,1]
  v_pk_mul_f16 v199, v82, v86 op_sel:[0,0] op_sel_hi:[0,1]
  v_mfma_f32_32x32x16_f16 v[150:165], v[218:221], v[206:209], v[150:165]
  v_pk_mul_f16 v200, v82, v88 op_sel:[0,0] op_sel_hi:[0,1]
  v_pk_mul_f16 v201, v82, v90 op_sel:[0,0] op_sel_hi:[0,1]
  ds_read_b128 v[230:233], v7 offset:208
  v_mfma_f32_32x32x16_f16 v[166:181], v[218:221], v[210:213], v[166:181]
  v_pk_mul_f16 v202, v83, v85 op_sel:[0,0] op_sel_hi:[0,1]
  v_pk_mul_f16 v203, v83, v87 op_sel:[0,0] op_sel_hi:[0,1]
  v_pk_mul_f16 v204, v83, v89 op_sel:[0,0] op_sel_hi:[0,1]
  v_mfma_f32_32x32x16_f16 v[8:23], v[214:217], v[210:213], v[8:23]
  v_pk_mul_f16 v205, v83, v91 op_sel:[0,0] op_sel_hi:[0,1]
  ds_read_b128 v[214:217], v7 offset:21376
  s_waitcnt lgkmcnt(2)
  v_mfma_f32_32x32x16_f16 v[118:133], v[222:225], v[198:201], v[118:133]
  v_pk_mul_f16 v206, v82, v66 op_sel:[0,0] op_sel_hi:[0,1]
  v_pk_mul_f16 v207, v82, v68 op_sel:[0,0] op_sel_hi:[0,1]
  v_mfma_f32_32x32x16_f16 v[150:165], v[226:229], v[198:201], v[150:165]
  v_pk_mul_f16 v208, v84, v86 op_sel:[0,0] op_sel_hi:[0,1]
  v_pk_mul_f16 v209, v84, v88 op_sel:[0,0] op_sel_hi:[0,1]
  ds_read_b128 v[218:221], v7 offset:224
  v_mfma_f32_32x32x16_f16 v[166:181], v[226:229], v[202:205], v[166:181]
  v_pk_mul_f16 v210, v83, v67 op_sel:[0,0] op_sel_hi:[0,1]
  v_pk_mul_f16 v211, v83, v69 op_sel:[0,0] op_sel_hi:[0,1]
  v_pk_mul_f16 v212, v85, v87 op_sel:[0,0] op_sel_hi:[0,1]
  v_mfma_f32_32x32x16_f16 v[8:23], v[222:225], v[202:205], v[8:23]
  v_pk_mul_f16 v213, v85, v89 op_sel:[0,0] op_sel_hi:[0,1]
  ds_read_b128 v[222:225], v7 offset:21392
  s_waitcnt lgkmcnt(2)
  v_mfma_f32_32x32x16_f16 v[118:133], v[230:233], v[206:209], v[118:133]
  v_pk_mul_f16 v198, v84, v90 op_sel:[0,0] op_sel_hi:[0,1]
  v_pk_mul_f16 v199, v84, v66 op_sel:[0,0] op_sel_hi:[0,1]
  v_mfma_f32_32x32x16_f16 v[150:165], v[214:217], v[206:209], v[150:165]
  v_pk_mul_f16 v200, v84, v68 op_sel:[0,0] op_sel_hi:[0,1]
  v_pk_mul_f16 v201, v84, v70 op_sel:[0,0] op_sel_hi:[0,1]
  ds_read_b128 v[226:229], v7 offset:240
  v_mfma_f32_32x32x16_f16 v[166:181], v[214:217], v[210:213], v[166:181]
  v_pk_mul_f16 v202, v85, v91 op_sel:[0,0] op_sel_hi:[0,1]
  v_pk_mul_f16 v203, v85, v67 op_sel:[0,0] op_sel_hi:[0,1]
  v_pk_mul_f16 v204, v85, v69 op_sel:[0,0] op_sel_hi:[0,1]
  v_mfma_f32_32x32x16_f16 v[8:23], v[230:233], v[210:213], v[8:23]
  v_pk_mul_f16 v205, v85, v71 op_sel:[0,0] op_sel_hi:[0,1]
  ds_read_b128 v[230:233], v7 offset:21408
  s_waitcnt lgkmcnt(2)
  v_mfma_f32_32x32x16_f16 v[118:133], v[218:221], v[198:201], v[118:133]
  v_pk_mul_f16 v206, v86, v88 op_sel:[0,0] op_sel_hi:[0,1]
  v_pk_mul_f16 v207, v86, v90 op_sel:[0,0] op_sel_hi:[0,1]
  v_mfma_f32_32x32x16_f16 v[150:165], v[222:225], v[198:201], v[150:165]
  v_pk_mul_f16 v208, v86, v66 op_sel:[0,0] op_sel_hi:[0,1]
  v_pk_mul_f16 v209, v86, v68 op_sel:[0,0] op_sel_hi:[0,1]
  ds_read_b128 v[214:217], v7 offset:256
  v_mfma_f32_32x32x16_f16 v[166:181], v[222:225], v[202:205], v[166:181]
  v_pk_mul_f16 v210, v87, v89 op_sel:[0,0] op_sel_hi:[0,1]
  v_pk_mul_f16 v211, v87, v91 op_sel:[0,0] op_sel_hi:[0,1]
  v_pk_mul_f16 v212, v87, v67 op_sel:[0,0] op_sel_hi:[0,1]
  v_mfma_f32_32x32x16_f16 v[8:23], v[218:221], v[202:205], v[8:23]
  v_pk_mul_f16 v213, v87, v69 op_sel:[0,0] op_sel_hi:[0,1]
  ds_read_b128 v[218:221], v7 offset:21424
  s_waitcnt lgkmcnt(2)
  v_mfma_f32_32x32x16_f16 v[118:133], v[226:229], v[206:209], v[118:133]
  v_pk_mul_f16 v198, v86, v70 op_sel:[0,0] op_sel_hi:[0,1]
  v_pk_mul_f16 v199, v86, v72 op_sel:[0,0] op_sel_hi:[0,1]
  v_mfma_f32_32x32x16_f16 v[150:165], v[230:233], v[206:209], v[150:165]
  v_pk_mul_f16 v200, v88, v90 op_sel:[0,0] op_sel_hi:[0,1]
  v_pk_mul_f16 v201, v88, v66 op_sel:[0,0] op_sel_hi:[0,1]
  ds_read_b128 v[222:225], v7 offset:272
  v_mfma_f32_32x32x16_f16 v[166:181], v[230:233], v[210:213], v[166:181]
  v_pk_mul_f16 v202, v87, v71 op_sel:[0,0] op_sel_hi:[0,1]
  v_pk_mul_f16 v203, v87, v73 op_sel:[0,0] op_sel_hi:[0,1]
  v_pk_mul_f16 v204, v89, v91 op_sel:[0,0] op_sel_hi:[0,1]
  v_mfma_f32_32x32x16_f16 v[8:23], v[226:229], v[210:213], v[8:23]
  v_pk_mul_f16 v205, v89, v67 op_sel:[0,0] op_sel_hi:[0,1]
  ds_read_b128 v[226:229], v7 offset:21440
  s_waitcnt lgkmcnt(2)
  v_mfma_f32_32x32x16_f16 v[118:133], v[214:217], v[198:201], v[118:133]
  v_pk_mul_f16 v206, v88, v68 op_sel:[0,0] op_sel_hi:[0,1]
  v_pk_mul_f16 v207, v88, v70 op_sel:[0,0] op_sel_hi:[0,1]
  v_mfma_f32_32x32x16_f16 v[150:165], v[218:221], v[198:201], v[150:165]
  v_pk_mul_f16 v208, v88, v72 op_sel:[0,0] op_sel_hi:[0,1]
  v_pk_mul_f16 v209, v88, v74 op_sel:[0,0] op_sel_hi:[0,1]
  ds_read_b128 v[230:233], v7 offset:288
  v_mfma_f32_32x32x16_f16 v[166:181], v[218:221], v[202:205], v[166:181]
  v_pk_mul_f16 v210, v89, v69 op_sel:[0,0] op_sel_hi:[0,1]
  v_pk_mul_f16 v211, v89, v71 op_sel:[0,0] op_sel_hi:[0,1]
  v_pk_mul_f16 v212, v89, v73 op_sel:[0,0] op_sel_hi:[0,1]
  v_mfma_f32_32x32x16_f16 v[8:23], v[214:217], v[202:205], v[8:23]
  v_pk_mul_f16 v213, v89, v75 op_sel:[0,0] op_sel_hi:[0,1]
  ds_read_b128 v[214:217], v7 offset:21456
  s_waitcnt lgkmcnt(2)
  v_mfma_f32_32x32x16_f16 v[118:133], v[222:225], v[206:209], v[118:133]
  v_pk_mul_f16 v198, v90, v66 op_sel:[0,0] op_sel_hi:[0,1]
  v_pk_mul_f16 v199, v90, v68 op_sel:[0,0] op_sel_hi:[0,1]
  v_mfma_f32_32x32x16_f16 v[150:165], v[226:229], v[206:209], v[150:165]
  v_pk_mul_f16 v200, v90, v70 op_sel:[0,0] op_sel_hi:[0,1]
  v_pk_mul_f16 v201, v90, v72 op_sel:[0,0] op_sel_hi:[0,1]
  ds_read_b128 v[218:221], v7 offset:304
  v_mfma_f32_32x32x16_f16 v[166:181], v[226:229], v[210:213], v[166:181]
  v_pk_mul_f16 v202, v91, v67 op_sel:[0,0] op_sel_hi:[0,1]
  v_pk_mul_f16 v203, v91, v69 op_sel:[0,0] op_sel_hi:[0,1]
  v_pk_mul_f16 v204, v91, v71 op_sel:[0,0] op_sel_hi:[0,1]
  v_mfma_f32_32x32x16_f16 v[8:23], v[222:225], v[210:213], v[8:23]
  v_pk_mul_f16 v205, v91, v73 op_sel:[0,0] op_sel_hi:[0,1]
  ds_read_b128 v[222:225], v7 offset:21472
  s_waitcnt lgkmcnt(2)
  v_mfma_f32_32x32x16_f16 v[118:133], v[230:233], v[198:201], v[118:133]
  v_pk_mul_f16 v206, v90, v74 op_sel:[0,0] op_sel_hi:[0,1]
  v_pk_mul_f16 v207, v90, v76 op_sel:[0,0] op_sel_hi:[0,1]
  v_mfma_f32_32x32x16_f16 v[150:165], v[214:217], v[198:201], v[150:165]
  v_pk_mul_f16 v208, v66, v66 op_sel:[0,0] op_sel_hi:[0,1]
  v_pk_mul_f16 v209, v70, v70 op_sel:[0,0] op_sel_hi:[0,1]
  ds_read_b128 v[226:229], v7 offset:320
  v_mfma_f32_32x32x16_f16 v[166:181], v[214:217], v[202:205], v[166:181]
  v_pk_mul_f16 v210, v91, v75 op_sel:[0,0] op_sel_hi:[0,1]
  v_pk_mul_f16 v211, v91, v77 op_sel:[0,0] op_sel_hi:[0,1]
  v_pk_mul_f16 v212, v67, v67 op_sel:[0,0] op_sel_hi:[0,1]
  v_mfma_f32_32x32x16_f16 v[8:23], v[230:233], v[202:205], v[8:23]
  v_pk_mul_f16 v213, v71, v71 op_sel:[0,0] op_sel_hi:[0,1]
  ds_read_b128 v[230:233], v7 offset:21488
  s_waitcnt lgkmcnt(2)
  v_mfma_f32_32x32x16_f16 v[118:133], v[218:221], v[206:209], v[118:133]
  v_pk_mul_f16 v198, v74, v74 op_sel:[0,0] op_sel_hi:[0,1]
  v_pk_mul_f16 v199, v78, v78 op_sel:[0,0] op_sel_hi:[0,1]
  v_mfma_f32_32x32x16_f16 v[150:165], v[222:225], v[206:209], v[150:165]
  v_pk_mul_f16 v200, v82, v82 op_sel:[0,0] op_sel_hi:[0,1]
  v_pk_mul_f16 v201, v86, v86 op_sel:[0,0] op_sel_hi:[0,1]
  ds_read_b128 v[214:217], v7 offset:336
  v_mfma_f32_32x32x16_f16 v[166:181], v[222:225], v[210:213], v[166:181]
  v_pk_mul_f16 v202, v75, v75 op_sel:[0,0] op_sel_hi:[0,1]
  v_pk_mul_f16 v203, v79, v79 op_sel:[0,0] op_sel_hi:[0,1]
  v_pk_mul_f16 v204, v83, v83 op_sel:[0,0] op_sel_hi:[0,1]
  v_mfma_f32_32x32x16_f16 v[8:23], v[218:221], v[210:213], v[8:23]
  v_pk_mul_f16 v205, v87, v87 op_sel:[0,0] op_sel_hi:[0,1]
  ds_read_b128 v[218:221], v7 offset:21504
  s_waitcnt lgkmcnt(2)
  v_mfma_f32_32x32x16_f16 v[118:133], v[226:229], v[198:201], v[118:133]
  v_pk_mul_f16 v206, v90, v90 op_sel:[0,0] op_sel_hi:[0,1]
  v_perm_b32 v207, v72, v68, s12
  v_pk_mul_f16 v207, v207, v207
  v_perm_b32 v208, v80, v76, s12
  v_mfma_f32_32x32x16_f16 v[150:165], v[230:233], v[198:201], v[150:165]
  v_pk_mul_f16 v208, v208, v208
  v_perm_b32 v209, v88, v84, s12
  v_pk_mul_f16 v209, v209, v209
  v_pk_mul_f16 v210, v91, v91 op_sel:[0,0] op_sel_hi:[0,1]
  v_mfma_f32_32x32x16_f16 v[166:181], v[230:233], v[202:205], v[166:181]
  v_perm_b32 v211, v73, v69, s12
  v_pk_mul_f16 v211, v211, v211
  v_perm_b32 v212, v81, v77, s12
  v_pk_mul_f16 v212, v212, v212
  v_mfma_f32_32x32x16_f16 v[8:23], v[226:229], v[202:205], v[8:23]
  v_perm_b32 v213, v89, v85, s12
  v_pk_mul_f16 v213, v213, v213
  s_waitcnt lgkmcnt(0)
  v_mfma_f32_32x32x16_f16 v[118:133], v[214:217], v[206:209], v[118:133]
  v_pk_mul_f16 v198, v92, v195
  v_pk_mul_f16 v199, v94, v195
  v_mfma_f32_32x32x16_f16 v[150:165], v[218:221], v[206:209], v[150:165]
  v_pk_mul_f16 v200, v96, v195
  v_pk_mul_f16 v201, v98, v195
  v_mfma_f32_32x32x16_f16 v[8:23], v[214:217], v[210:213], v[8:23]
  v_pk_mul_f16 v202, v105, v195
  v_pk_mul_f16 v203, v107, v195
  v_pk_mul_f16 v204, v109, v195
  v_mfma_f32_32x32x16_f16 v[166:181], v[218:221], v[210:213], v[166:181]
  v_pk_mul_f16 v205, v111, v195
  v_mfma_f32_32x32x16_f16 v[134:149], v[234:237], v[198:201], 0
  v_pk_mul_f16 v206, v92, v93 op_sel:[0,0] op_sel_hi:[0,1]
  v_pk_mul_f16 v207, v92, v94 op_sel:[0,0] op_sel_hi:[0,1]
  v_pk_mul_f16 v208, v92, v95 op_sel:[0,0] op_sel_hi:[0,1]
  v_pk_mul_f16 v209, v92, v96 op_sel:[0,0] op_sel_hi:[0,1]
  v_fmac_f32 v182, v118, v150
  v_fmac_f32 v183, v119, v151
  v_fmac_f32 v184, v120, v152
  v_fmac_f32 v185, v121, v153
  v_mfma_f32_32x32x16_f16 v[24:39], v[234:237], v[202:205], 0
  v_pk_mul_f16 v210, v105, v106 op_sel:[0,0] op_sel_hi:[0,1]
  v_pk_mul_f16 v211, v105, v107 op_sel:[0,0] op_sel_hi:[0,1]
  v_pk_mul_f16 v212, v105, v108 op_sel:[0,0] op_sel_hi:[0,1]
  v_pk_mul_f16 v213, v105, v109 op_sel:[0,0] op_sel_hi:[0,1]
  v_fmac_f32 v186, v122, v154
  v_fmac_f32 v187, v123, v155
  v_fmac_f32 v188, v124, v156
  v_fmac_f32 v189, v125, v157
  v_mfma_f32_32x32x16_f16 v[134:149], v[246:249], v[206:209], v[134:149]
  v_pk_mul_f16 v198, v92, v97 op_sel:[0,0] op_sel_hi:[0,1]
  v_pk_mul_f16 v199, v92, v98 op_sel:[0,0] op_sel_hi:[0,1]
  v_fmac_f32 v190, v126, v158
  v_fmac_f32 v191, v127, v159
  v_fmac_f32 v192, v128, v160
  v_fmac_f32 v193, v129, v161
  v_mfma_f32_32x32x16_f16 v[24:39], v[246:249], v[210:213], v[24:39]
  v_pk_mul_f16 v200, v93, v94 op_sel:[0,0] op_sel_hi:[0,1]
  v_pk_mul_f16 v201, v93, v95 op_sel:[0,0] op_sel_hi:[0,1]
  v_fmac_f32 v194, v130, v162
  v_mfma_f32_32x32x16_f16 v[150:165], v[242:245], v[210:213], 0
  v_pk_mul_f16 v202, v105, v110 op_sel:[0,0] op_sel_hi:[0,1]
  v_pk_mul_f16 v203, v105, v111 op_sel:[0,0] op_sel_hi:[0,1]
  v_pk_mul_f16 v204, v106, v107 op_sel:[0,0] op_sel_hi:[0,1]
  v_fmac_f32 v182, v8, v166
  v_fmac_f32 v183, v9, v167
  v_mfma_f32_32x32x16_f16 v[118:133], v[242:245], v[206:209], 0
  v_pk_mul_f16 v205, v106, v108 op_sel:[0,0] op_sel_hi:[0,1]
  v_fmac_f32 v184, v10, v168
  v_fmac_f32 v185, v11, v169
  v_mfma_f32_32x32x16_f16 v[118:133], v[250:253], v[198:201], v[118:133]
  v_pk_mul_f16 v206, v93, v96 op_sel:[0,0] op_sel_hi:[0,1]
  v_pk_mul_f16 v207, v93, v97 op_sel:[0,0] op_sel_hi:[0,1]
  v_fmac_f32 v186, v12, v170
  v_fmac_f32 v187, v13, v171
  v_mfma_f32_32x32x16_f16 v[134:149], v[40:43], v[198:201], v[134:149]
  v_pk_mul_f16 v208, v93, v98 op_sel:[0,0] op_sel_hi:[0,1]
  v_pk_mul_f16 v209, v93, v99 op_sel:[0,0] op_sel_hi:[0,1]
  v_fmac_f32 v188, v14, v172
  v_fmac_f32 v189, v15, v173
  v_mfma_f32_32x32x16_f16 v[24:39], v[40:43], v[202:205], v[24:39]
  v_pk_mul_f16 v210, v106, v109 op_sel:[0,0] op_sel_hi:[0,1]
  v_pk_mul_f16 v211, v106, v110 op_sel:[0,0] op_sel_hi:[0,1]
  v_pk_mul_f16 v212, v106, v111 op_sel:[0,0] op_sel_hi:[0,1]
  v_fmac_f32 v190, v16, v174
  v_fmac_f32 v191, v17, v175
  v_mfma_f32_32x32x16_f16 v[150:165], v[250:253], v[202:205], v[150:165]
  v_pk_mul_f16 v213, v106, v112 op_sel:[0,0] op_sel_hi:[0,1]
  v_fmac_f32 v192, v18, v176
  v_fmac_f32 v193, v19, v177
  v_mfma_f32_32x32x16_f16 v[118:133], v[44:47], v[206:209], v[118:133]
  v_pk_mul_f16 v198, v94, v95 op_sel:[0,0] op_sel_hi:[0,1]
  v_pk_mul_f16 v199, v94, v96 op_sel:[0,0] op_sel_hi:[0,1]
  v_fmac_f32 v194, v20, v178
  v_mfma_f32_32x32x16_f16 v[134:149], v[48:51], v[206:209], v[134:149]
  v_pk_mul_f16 v200, v94, v97 op_sel:[0,0] op_sel_hi:[0,1]
  v_pk_mul_f16 v201, v94, v98 op_sel:[0,0] op_sel_hi:[0,1]
  v_lshrrev_b32 v197, 5, v1
  v_mul_u32_u24 v4, 784, v197
  v_mfma_f32_32x32x16_f16 v[24:39], v[48:51], v[210:213], v[24:39]
  v_pk_mul_f16 v202, v107, v108 op_sel:[0,0] op_sel_hi:[0,1]
  v_pk_mul_f16 v203, v107, v109 op_sel:[0,0] op_sel_hi:[0,1]
  v_pk_mul_f16 v204, v107, v110 op_sel:[0,0] op_sel_hi:[0,1]
  v_mfma_f32_32x32x16_f16 v[150:165], v[44:47], v[210:213], v[150:165]
  v_pk_mul_f16 v205, v107, v111 op_sel:[0,0] op_sel_hi:[0,1]
  v_lshlrev_b32 v197, 2, v4
  v_add_u32 v197, 40704, v197
  ds_read_b128 v[222:225], v7 offset:21232
  v_mfma_f32_32x32x16_f16 v[118:133], v[52:55], v[198:201], v[118:133]
  v_pk_mul_f16 v206, v94, v99 op_sel:[0,0] op_sel_hi:[0,1]
  v_pk_mul_f16 v207, v94, v100 op_sel:[0,0] op_sel_hi:[0,1]
  v_add_u32 v4, 40704, v4
  ds_read_b32 v66, v197
  v_mfma_f32_32x32x16_f16 v[134:149], v[56:59], v[198:201], v[134:149]
  v_pk_mul_f16 v208, v95, v96 op_sel:[0,0] op_sel_hi:[0,1]
  v_pk_mul_f16 v209, v95, v97 op_sel:[0,0] op_sel_hi:[0,1]
  ds_read_b32 v79, v197 offset:21168
  ds_read_b32 v67, v197 offset:784
  ds_read_b128 v[226:229], v7 offset:80
  v_mfma_f32_32x32x16_f16 v[24:39], v[56:59], v[202:205], v[24:39]
  v_pk_mul_f16 v210, v107, v112 op_sel:[0,0] op_sel_hi:[0,1]
  v_pk_mul_f16 v211, v107, v113 op_sel:[0,0] op_sel_hi:[0,1]
  v_pk_mul_f16 v212, v108, v109 op_sel:[0,0] op_sel_hi:[0,1]
  v_mfma_f32_32x32x16_f16 v[150:165], v[52:55], v[202:205], v[150:165]
  v_pk_mul_f16 v213, v108, v110 op_sel:[0,0] op_sel_hi:[0,1]
  ds_read_b32 v80, v197 offset:21952
  ds_read_b32 v68, v197 offset:1568
  ds_read_b128 v[230:233], v7 offset:21248
  s_waitcnt lgkmcnt(7)
  v_mfma_f32_32x32x16_f16 v[118:133], v[60:63], v[206:209], v[118:133]
  v_pk_mul_f16 v198, v95, v98 op_sel:[0,0] op_sel_hi:[0,1]
  v_pk_mul_f16 v199, v95, v99 op_sel:[0,0] op_sel_hi:[0,1]
  ds_read_b32 v81, v197 offset:22736
  ds_read_b32 v69, v197 offset:2352
  v_mfma_f32_32x32x16_f16 v[134:149], v[222:225], v[206:209], v[134:149]
  v_pk_mul_f16 v200, v95, v100 op_sel:[0,0] op_sel_hi:[0,1]
  v_pk_mul_f16 v201, v95, v101 op_sel:[0,0] op_sel_hi:[0,1]
  ds_read_b32 v82, v197 offset:23520
  ds_read_b32 v70, v197 offset:6272
  ds_read_b128 v[214:217], v7 offset:96
  v_mfma_f32_32x32x16_f16 v[24:39], v[222:225], v[210:213], v[24:39]
  v_pk_mul_f16 v202, v108, v111 op_sel:[0,0] op_sel_hi:[0,1]
  v_pk_mul_f16 v203, v108, v112 op_sel:[0,0] op_sel_hi:[0,1]
  v_pk_mul_f16 v204, v108, v113 op_sel:[0,0] op_sel_hi:[0,1]
  v_mfma_f32_32x32x16_f16 v[150:165], v[60:63], v[210:213], v[150:165]
  v_pk_mul_f16 v205, v108, v114 op_sel:[0,0] op_sel_hi:[0,1]
  ds_read_b32 v83, v197 offset:27440
  ds_read_b32 v71, v197 offset:7056
  ds_read_b128 v[218:221], v7 offset:21264
  s_waitcnt lgkmcnt(8)
  v_mfma_f32_32x32x16_f16 v[118:133], v[226:229], v[198:201], v[118:133]
  v_pk_mul_f16 v206, v96, v97 op_sel:[0,0] op_sel_hi:[0,1]
  v_pk_mul_f16 v207, v96, v98 op_sel:[0,0] op_sel_hi:[0,1]
  ds_read_b32 v84, v197 offset:28224
  ds_read_b32 v72, v197 offset:7840
  v_mfma_f32_32x32x16_f16 v[134:149], v[230:233], v[198:201], v[134:149]
  v_pk_mul_f16 v208, v96, v99 op_sel:[0,0] op_sel_hi:[0,1]
  v_pk_mul_f16 v209, v96, v100 op_sel:[0,0] op_sel_hi:[0,1]
  ds_read_b32 v85, v197 offset:29008
  ds_read_b32 v73, v197 offset:8624
  ds_read_b128 v[222:225], v7 offset:112
  v_mfma_f32_32x32x16_f16 v[24:39], v[230:233], v[202:205], v[24:39]
  v_pk_mul_f16 v210, v109, v110 op_sel:[0,0] op_sel_hi:[0,1]
  v_pk_mul_f16 v211, v109, v111 op_sel:[0,0] op_sel_hi:[0,1]
  v_pk_mul_f16 v212, v109, v112 op_sel:[0,0] op_sel_hi:[0,1]
  v_mfma_f32_32x32x16_f16 v[150:165], v[226:229], v[202:205], v[150:165]
  v_pk_mul_f16 v213, v109, v113 op_sel:[0,0] op_sel_hi:[0,1]
  ds_read_b32 v86, v197 offset:29792
  ds_read_b32 v74, v197 offset:12544
  ds_read_b128 v[226:229], v7 offset:21280
  s_waitcnt lgkmcnt(8)
  v_mfma_f32_32x32x16_f16 v[118:133], v[214:217], v[206:209], v[118:133]
  v_pk_mul_f16 v198, v96, v101 op_sel:[0,0] op_sel_hi:[0,1]
  v_pk_mul_f16 v199, v96, v102 op_sel:[0,0] op_sel_hi:[0,1]
  ds_read_b32 v87, v197 offset:33712
  ds_read_b32 v75, v197 offset:13328
  v_mfma_f32_32x32x16_f16 v[134:149], v[218:221], v[206:209], v[134:149]
  v_pk_mul_f16 v200, v97, v98 op_sel:[0,0] op_sel_hi:[0,1]
  v_pk_mul_f16 v201, v97, v99 op_sel:[0,0] op_sel_hi:[0,1]
  ds_read_b32 v88, v197 offset:34496
  ds_read_b32 v76, v197 offset:14112
  ds_read_b128 v[230:233], v7 offset:128
  v_mfma_f32_32x32x16_f16 v[24:39], v[218:221], v[210:213], v[24:39]
  v_pk_mul_f16 v202, v109, v114 op_sel:[0,0] op_sel_hi:[0,1]
  v_pk_mul_f16 v203, v109, v115 op_sel:[0,0] op_sel_hi:[0,1]
  v_pk_mul_f16 v204, v110, v111 op_sel:[0,0] op_sel_hi:[0,1]
  v_mfma_f32_32x32x16_f16 v[150:165], v[214:217], v[210:213], v[150:165]
  v_pk_mul_f16 v205, v110, v112 op_sel:[0,0] op_sel_hi:[0,1]
  ds_read_b32 v89, v197 offset:35280
  ds_read_b32 v77, v197 offset:14896
  ds_read_b128 v[214:217], v7 offset:21296
  s_waitcnt lgkmcnt(8)
  v_mfma_f32_32x32x16_f16 v[118:133], v[222:225], v[198:201], v[118:133]
  v_pk_mul_f16 v206, v97, v100 op_sel:[0,0] op_sel_hi:[0,1]
  v_pk_mul_f16 v207, v97, v101 op_sel:[0,0] op_sel_hi:[0,1]
  ds_read_b32 v90, v197 offset:36064
  ds_read_b32 v78, v4 offset:18816
  v_mfma_f32_32x32x16_f16 v[134:149], v[226:229], v[198:201], v[134:149]
  v_pk_mul_f16 v208, v97, v102 op_sel:[0,0] op_sel_hi:[0,1]
  v_pk_mul_f16 v209, v97, v103 op_sel:[0,0] op_sel_hi:[0,1]
  ds_read_b32 v91, v4 offset:39984
  v_add3_u32 v66, v66, v79, v3
  ds_read_b128 v[218:221], v7 offset:144
  v_mfma_f32_32x32x16_f16 v[24:39], v[226:229], v[202:205], v[24:39]
  v_pk_mul_f16 v210, v110, v113 op_sel:[0,0] op_sel_hi:[0,1]
  v_pk_mul_f16 v211, v110, v114 op_sel:[0,0] op_sel_hi:[0,1]
  v_pk_mul_f16 v212, v110, v115 op_sel:[0,0] op_sel_hi:[0,1]
  v_mfma_f32_32x32x16_f16 v[150:165], v[222:225], v[202:205], v[150:165]
  v_pk_mul_f16 v213, v110, v116 op_sel:[0,0] op_sel_hi:[0,1]
  v_add3_u32 v67, v67, v80, v3
  v_add3_u32 v68, v68, v81, v3
  ds_read_b128 v[222:225], v7 offset:21312
  s_waitcnt lgkmcnt(5)
  v_mfma_f32_32x32x16_f16 v[118:133], v[230:233], v[206:209], v[118:133]
  v_pk_mul_f16 v198, v98, v99 op_sel:[0,0] op_sel_hi:[0,1]
  v_pk_mul_f16 v199, v98, v100 op_sel:[0,0] op_sel_hi:[0,1]
  v_add3_u32 v69, v69, v82, v3
  v_add3_u32 v70, v70, v83, v3
  v_mfma_f32_32x32x16_f16 v[134:149], v[214:217], v[206:209], v[134:149]
  v_pk_mul_f16 v200, v98, v101 op_sel:[0,0] op_sel_hi:[0,1]
  v_pk_mul_f16 v201, v98, v102 op_sel:[0,0] op_sel_hi:[0,1]
  v_add3_u32 v71, v71, v84, v3
  v_add3_u32 v72, v72, v85, v3
  ds_read_b128 v[226:229], v7 offset:160
  v_mfma_f32_32x32x16_f16 v[24:39], v[214:217], v[210:213], v[24:39]
  v_pk_mul_f16 v202, v111, v112 op_sel:[0,0] op_sel_hi:[0,1]
  v_pk_mul_f16 v203, v111, v113 op_sel:[0,0] op_sel_hi:[0,1]
  v_pk_mul_f16 v204, v111, v114 op_sel:[0,0] op_sel_hi:[0,1]
  v_mfma_f32_32x32x16_f16 v[150:165], v[230:233], v[210:213], v[150:165]
  v_pk_mul_f16 v205, v111, v115 op_sel:[0,0] op_sel_hi:[0,1]
  v_add3_u32 v73, v73, v86, v3
  v_add3_u32 v74, v74, v87, v3
  ds_read_b128 v[230:233], v7 offset:21328
  s_waitcnt lgkmcnt(2)
  v_mfma_f32_32x32x16_f16 v[118:133], v[218:221], v[198:201], v[118:133]
  v_pk_mul_f16 v206, v98, v103 op_sel:[0,0] op_sel_hi:[0,1]
  v_pk_mul_f16 v207, v98, v104 op_sel:[0,0] op_sel_hi:[0,1]
  v_add3_u32 v75, v75, v88, v3
  v_add3_u32 v76, v76, v89, v3
  v_mfma_f32_32x32x16_f16 v[134:149], v[222:225], v[198:201], v[134:149]
  v_pk_mul_f16 v208, v99, v100 op_sel:[0,0] op_sel_hi:[0,1]
  v_pk_mul_f16 v209, v99, v101 op_sel:[0,0] op_sel_hi:[0,1]
  v_add3_u32 v77, v77, v90, v3
  v_add3_u32 v78, v78, v91, v3
  ds_read_b128 v[214:217], v7 offset:176
  v_mfma_f32_32x32x16_f16 v[24:39], v[222:225], v[202:205], v[24:39]
  v_pk_mul_f16 v210, v111, v116 op_sel:[0,0] op_sel_hi:[0,1]
  v_pk_mul_f16 v211, v111, v117 op_sel:[0,0] op_sel_hi:[0,1]
  v_pk_mul_f16 v212, v112, v113 op_sel:[0,0] op_sel_hi:[0,1]
  v_mfma_f32_32x32x16_f16 v[150:165], v[218:221], v[202:205], v[150:165]
  v_pk_mul_f16 v213, v112, v114 op_sel:[0,0] op_sel_hi:[0,1]
  v_and_b32 v5, 15, v1
  s_lshl_b32 s5, s3, 8
  ds_read_b128 v[218:221], v7 offset:21344
  s_waitcnt lgkmcnt(2)
  v_mfma_f32_32x32x16_f16 v[118:133], v[226:229], v[206:209], v[118:133]
  v_pk_mul_f16 v198, v99, v102 op_sel:[0,0] op_sel_hi:[0,1]
  v_pk_mul_f16 v199, v99, v103 op_sel:[0,0] op_sel_hi:[0,1]
  s_add_u32 s5, s5, 84992
  v_lshl_add_u32 v8, v1, 2, s5
  v_mfma_f32_32x32x16_f16 v[134:149], v[230:233], v[206:209], v[134:149]
  v_pk_mul_f16 v200, v99, v104 op_sel:[0,0] op_sel_hi:[0,1]
  v_pk_mul_f16 v201, v99, v92 op_sel:[0,0] op_sel_hi:[0,1]
  v_lshlrev_b32 v5, 1, v5
  s_lshl_b32 s13, s2, 2
  ds_read_b128 v[222:225], v7 offset:192
  v_mfma_f32_32x32x16_f16 v[24:39], v[230:233], v[210:213], v[24:39]
  v_pk_mul_f16 v202, v112, v115 op_sel:[0,0] op_sel_hi:[0,1]
  v_pk_mul_f16 v203, v112, v116 op_sel:[0,0] op_sel_hi:[0,1]
  v_pk_mul_f16 v204, v112, v117 op_sel:[0,0] op_sel_hi:[0,1]
  v_mfma_f32_32x32x16_f16 v[150:165], v[226:229], v[210:213], v[150:165]
  v_pk_mul_f16 v205, v112, v105 op_sel:[0,0] op_sel_hi:[0,1]
  s_add_u32 s13, s13, s3
  s_lshl_b32 s13, s13, 5
  ds_read_b128 v[226:229], v7 offset:21360
  s_waitcnt lgkmcnt(2)
  v_mfma_f32_32x32x16_f16 v[118:133], v[214:217], v[198:201], v[118:133]
  v_pk_mul_f16 v206, v100, v101 op_sel:[0,0] op_sel_hi:[0,1]
  v_pk_mul_f16 v207, v100, v102 op_sel:[0,0] op_sel_hi:[0,1]
  v_ldexp_f32 v182, v182, v66
  v_ldexp_f32 v183, v183, v67
  v_mfma_f32_32x32x16_f16 v[134:149], v[218:221], v[198:201], v[134:149]
  v_pk_mul_f16 v208, v100, v103 op_sel:[0,0] op_sel_hi:[0,1]
  v_pk_mul_f16 v209, v100, v104 op_sel:[0,0] op_sel_hi:[0,1]
  v_ldexp_f32 v184, v184, v68
  v_ldexp_f32 v185, v185, v69
  ds_read_b128 v[230:233], v7 offset:208
  v_mfma_f32_32x32x16_f16 v[24:39], v[218:221], v[202:205], v[24:39]
  v_pk_mul_f16 v210, v113, v114 op_sel:[0,0] op_sel_hi:[0,1]
  v_pk_mul_f16 v211, v113, v115 op_sel:[0,0] op_sel_hi:[0,1]
  v_pk_mul_f16 v212, v113, v116 op_sel:[0,0] op_sel_hi:[0,1]
  v_mfma_f32_32x32x16_f16 v[150:165], v[214:217], v[202:205], v[150:165]
  v_pk_mul_f16 v213, v113, v117 op_sel:[0,0] op_sel_hi:[0,1]
  v_ldexp_f32 v186, v186, v70
  v_ldexp_f32 v187, v187, v71
  ds_read_b128 v[214:217], v7 offset:21376
  s_waitcnt lgkmcnt(2)
  v_mfma_f32_32x32x16_f16 v[118:133], v[222:225], v[206:209], v[118:133]
  v_pk_mul_f16 v198, v100, v92 op_sel:[0,0] op_sel_hi:[0,1]
  v_pk_mul_f16 v199, v100, v93 op_sel:[0,0] op_sel_hi:[0,1]
  v_ldexp_f32 v188, v188, v72
  v_ldexp_f32 v189, v189, v73
  v_mfma_f32_32x32x16_f16 v[134:149], v[226:229], v[206:209], v[134:149]
  v_pk_mul_f16 v200, v101, v102 op_sel:[0,0] op_sel_hi:[0,1]
  v_pk_mul_f16 v201, v101, v103 op_sel:[0,0] op_sel_hi:[0,1]
  v_ldexp_f32 v190, v190, v74
  v_ldexp_f32 v191, v191, v75
  ds_read_b128 v[218:221], v7 offset:224
  v_mfma_f32_32x32x16_f16 v[24:39], v[226:229], v[210:213], v[24:39]
  v_pk_mul_f16 v202, v113, v105 op_sel:[0,0] op_sel_hi:[0,1]
  v_pk_mul_f16 v203, v113, v106 op_sel:[0,0] op_sel_hi:[0,1]
  v_pk_mul_f16 v204, v114, v115 op_sel:[0,0] op_sel_hi:[0,1]
  v_mfma_f32_32x32x16_f16 v[150:165], v[222:225], v[210:213], v[150:165]
  v_pk_mul_f16 v205, v114, v116 op_sel:[0,0] op_sel_hi:[0,1]
  v_ldexp_f32 v192, v192, v76
  v_ldexp_f32 v193, v193, v77
  ds_read_b128 v[222:225], v7 offset:21392
  s_waitcnt lgkmcnt(2)
  v_mfma_f32_32x32x16_f16 v[118:133], v[230:233], v[198:201], v[118:133]
  v_pk_mul_f16 v206, v101, v104 op_sel:[0,0] op_sel_hi:[0,1]
  v_pk_mul_f16 v207, v101, v92 op_sel:[0,0] op_sel_hi:[0,1]
  v_ldexp_f32 v194, v194, v78
  v_add_f32 v182, v182, v186
  v_mfma_f32_32x32x16_f16 v[134:149], v[214:217], v[198:201], v[134:149]
  v_pk_mul_f16 v208, v101, v93 op_sel:[0,0] op_sel_hi:[0,1]
  v_pk_mul_f16 v209, v101, v94 op_sel:[0,0] op_sel_hi:[0,1]
  v_add_f32 v183, v183, v187
  v_add_f32 v184, v184, v188
  ds_read_b128 v[226:229], v7 offset:240
  v_mfma_f32_32x32x16_f16 v[24:39], v[214:217], v[202:205], v[24:39]
  v_pk_mul_f16 v210, v114, v117 op_sel:[0,0] op_sel_hi:[0,1]
  v_pk_mul_f16 v211, v114, v105 op_sel:[0,0] op_sel_hi:[0,1]
  v_pk_mul_f16 v212, v114, v106 op_sel:[0,0] op_sel_hi:[0,1]
  v_mfma_f32_32x32x16_f16 v[150:165], v[230:233], v[202:205], v[150:165]
  v_pk_mul_f16 v213, v114, v107 op_sel:[0,0] op_sel_hi:[0,1]
  v_add_f32 v185, v185, v189
  v_add_f32 v182, v182, v190
  ds_read_b128 v[230:233], v7 offset:21408
  s_waitcnt lgkmcnt(2)
  v_mfma_f32_32x32x16_f16 v[118:133], v[218:221], v[206:209], v[118:133]
  v_pk_mul_f16 v198, v102, v103 op_sel:[0,0] op_sel_hi:[0,1]
  v_pk_mul_f16 v199, v102, v104 op_sel:[0,0] op_sel_hi:[0,1]
  v_add_f32 v183, v183, v191
  v_add_f32 v184, v184, v192
  v_mfma_f32_32x32x16_f16 v[134:149], v[222:225], v[206:209], v[134:149]
  v_pk_mul_f16 v200, v102, v92 op_sel:[0,0] op_sel_hi:[0,1]
  v_pk_mul_f16 v201, v102, v93 op_sel:[0,0] op_sel_hi:[0,1]
  v_add_f32 v185, v185, v193
  v_add_f32 v182, v182, v194
  ds_read_b128 v[214:217], v7 offset:256
  v_mfma_f32_32x32x16_f16 v[24:39], v[222:225], v[210:213], v[24:39]
  v_pk_mul_f16 v202, v115, v116 op_sel:[0,0] op_sel_hi:[0,1]
  v_pk_mul_f16 v203, v115, v117 op_sel:[0,0] op_sel_hi:[0,1]
  v_pk_mul_f16 v204, v115, v105 op_sel:[0,0] op_sel_hi:[0,1]
  v_mfma_f32_32x32x16_f16 v[150:165], v[218:221], v[210:213], v[150:165]
  v_pk_mul_f16 v205, v115, v106 op_sel:[0,0] op_sel_hi:[0,1]
  v_add_f32 v183, s96, v183
  ds_read_b128 v[218:221], v7 offset:21424
  s_waitcnt lgkmcnt(2)
  v_mfma_f32_32x32x16_f16 v[118:133], v[226:229], v[198:201], v[118:133]
  v_pk_mul_f16 v206, v102, v94 op_sel:[0,0] op_sel_hi:[0,1]
  v_pk_mul_f16 v207, v102, v95 op_sel:[0,0] op_sel_hi:[0,1]
  v_mfma_f32_32x32x16_f16 v[134:149], v[230:233], v[198:201], v[134:149]
  v_pk_mul_f16 v208, v103, v104 op_sel:[0,0] op_sel_hi:[0,1]
  v_pk_mul_f16 v209, v103, v92 op_sel:[0,0] op_sel_hi:[0,1]
  ds_read_b128 v[222:225], v7 offset:272
  v_mfma_f32_32x32x16_f16 v[24:39], v[230:233], v[202:205], v[24:39]
  v_pk_mul_f16 v210, v115, v107 op_sel:[0,0] op_sel_hi:[0,1]
  v_pk_mul_f16 v211, v115, v108 op_sel:[0,0] op_sel_hi:[0,1]
  v_pk_mul_f16 v212, v116, v117 op_sel:[0,0] op_sel_hi:[0,1]
  v_mfma_f32_32x32x16_f16 v[150:165], v[226:229], v[202:205], v[150:165]
  v_pk_mul_f16 v213, v116, v105 op_sel:[0,0] op_sel_hi:[0,1]
  ds_read_b128 v[226:229], v7 offset:21440
  s_waitcnt lgkmcnt(2)
  v_mfma_f32_32x32x16_f16 v[118:133], v[214:217], v[206:209], v[118:133]
  v_pk_mul_f16 v198, v103, v93 op_sel:[0,0] op_sel_hi:[0,1]
  v_pk_mul_f16 v199, v103, v94 op_sel:[0,0] op_sel_hi:[0,1]
  v_mfma_f32_32x32x16_f16 v[134:149], v[218:221], v[206:209], v[134:149]
  v_pk_mul_f16 v200, v103, v95 op_sel:[0,0] op_sel_hi:[0,1]
  v_pk_mul_f16 v201, v103, v96 op_sel:[0,0] op_sel_hi:[0,1]
  ds_read_b128 v[230:233], v7 offset:288
  v_mfma_f32_32x32x16_f16 v[24:39], v[218:221], v[210:213], v[24:39]
  v_pk_mul_f16 v202, v116, v106 op_sel:[0,0] op_sel_hi:[0,1]
  v_pk_mul_f16 v203, v116, v107 op_sel:[0,0] op_sel_hi:[0,1]
  v_pk_mul_f16 v204, v116, v108 op_sel:[0,0] op_sel_hi:[0,1]
  v_mfma_f32_32x32x16_f16 v[150:165], v[214:217], v[210:213], v[150:165]
  v_pk_mul_f16 v205, v116, v109 op_sel:[0,0] op_sel_hi:[0,1]
  ds_read_b128 v[214:217], v7 offset:21456
  s_waitcnt lgkmcnt(2)
  v_mfma_f32_32x32x16_f16 v[118:133], v[222:225], v[198:201], v[118:133]
  v_pk_mul_f16 v206, v104, v92 op_sel:[0,0] op_sel_hi:[0,1]
  v_pk_mul_f16 v207, v104, v93 op_sel:[0,0] op_sel_hi:[0,1]
  v_mfma_f32_32x32x16_f16 v[134:149], v[226:229], v[198:201], v[134:149]
  v_pk_mul_f16 v208, v104, v94 op_sel:[0,0] op_sel_hi:[0,1]
  v_pk_mul_f16 v209, v104, v95 op_sel:[0,0] op_sel_hi:[0,1]
  ds_read_b128 v[218:221], v7 offset:304
  v_mfma_f32_32x32x16_f16 v[24:39], v[226:229], v[202:205], v[24:39]
  v_pk_mul_f16 v210, v117, v105 op_sel:[0,0] op_sel_hi:[0,1]
  v_pk_mul_f16 v211, v117, v106 op_sel:[0,0] op_sel_hi:[0,1]
  v_pk_mul_f16 v212, v117, v107 op_sel:[0,0] op_sel_hi:[0,1]
  v_mfma_f32_32x32x16_f16 v[150:165], v[222:225], v[202:205], v[150:165]
  v_pk_mul_f16 v213, v117, v108 op_sel:[0,0] op_sel_hi:[0,1]
  ds_read_b128 v[222:225], v7 offset:21472
  s_waitcnt lgkmcnt(2)
  v_mfma_f32_32x32x16_f16 v[118:133], v[230:233], v[206:209], v[118:133]
  v_pk_mul_f16 v198, v104, v96 op_sel:[0,0] op_sel_hi:[0,1]
  v_pk_mul_f16 v199, v104, v97 op_sel:[0,0] op_sel_hi:[0,1]
  v_mfma_f32_32x32x16_f16 v[134:149], v[214:217], v[206:209], v[134:149]
  v_pk_mul_f16 v200, v92, v92 op_sel:[0,0] op_sel_hi:[0,1]
  v_pk_mul_f16 v201, v94, v94 op_sel:[0,0] op_sel_hi:[0,1]
  ds_read_b128 v[226:229], v7 offset:320
  v_mfma_f32_32x32x16_f16 v[24:39], v[214:217], v[210:213], v[24:39]
  v_pk_mul_f16 v202, v117, v109 op_sel:[0,0] op_sel_hi:[0,1]
  v_pk_mul_f16 v203, v117, v110 op_sel:[0,0] op_sel_hi:[0,1]
  v_pk_mul_f16 v204, v105, v105 op_sel:[0,0] op_sel_hi:[0,1]
  v_mfma_f32_32x32x16_f16 v[150:165], v[230:233], v[210:213], v[150:165]
  v_pk_mul_f16 v205, v107, v107 op_sel:[0,0] op_sel_hi:[0,1]
  ds_read_b128 v[230:233], v7 offset:21488
  s_waitcnt lgkmcnt(2)
  v_mfma_f32_32x32x16_f16 v[118:133], v[218:221], v[198:201], v[118:133]
  v_pk_mul_f16 v206, v96, v96 op_sel:[0,0] op_sel_hi:[0,1]
  v_pk_mul_f16 v207, v98, v98 op_sel:[0,0] op_sel_hi:[0,1]
  ds_read_b32 v187, v2 offset:4
  ds_read_b32 v10, v8
  ds_read_b32 v11, v8 offset:14336
  ds_read_b32 v12, v8 offset:28672
  ds_read_b32 v13, v8 offset:43008
  v_mfma_f32_32x32x16_f16 v[134:149], v[222:225], v[198:201], v[134:149]
  v_pk_mul_f16 v208, v100, v100 op_sel:[0,0] op_sel_hi:[0,1]
  v_pk_mul_f16 v209, v102, v102 op_sel:[0,0] op_sel_hi:[0,1]
  ds_read_b128 v[214:217], v7 offset:336
  v_mfma_f32_32x32x16_f16 v[24:39], v[222:225], v[202:205], v[24:39]
  v_pk_mul_f16 v210, v109, v109 op_sel:[0,0] op_sel_hi:[0,1]
  v_pk_mul_f16 v211, v111, v111 op_sel:[0,0] op_sel_hi:[0,1]
  v_pk_mul_f16 v212, v113, v113 op_sel:[0,0] op_sel_hi:[0,1]
  v_mfma_f32_32x32x16_f16 v[150:165], v[218:221], v[202:205], v[150:165]
  v_pk_mul_f16 v213, v115, v115 op_sel:[0,0] op_sel_hi:[0,1]
  ds_read_b128 v[218:221], v7 offset:21504
  s_waitcnt lgkmcnt(7)
  v_mfma_f32_32x32x16_f16 v[118:133], v[226:229], v[206:209], v[118:133]
  v_pk_mul_f16 v198, v104, v104 op_sel:[0,0] op_sel_hi:[0,1]
  v_perm_b32 v199, v95, v93, s12
  v_pk_mul_f16 v199, v199, v199
  v_perm_b32 v200, v99, v97, s12
  v_mfma_f32_32x32x16_f16 v[134:149], v[230:233], v[206:209], v[134:149]
  v_pk_mul_f16 v200, v200, v200
  v_perm_b32 v201, v103, v101, s12
  v_pk_mul_f16 v201, v201, v201
  v_pk_mul_f16 v202, v117, v117 op_sel:[0,0] op_sel_hi:[0,1]
  s_waitcnt lgkmcnt(6)
  v_readfirstlane_b32 s10, v187
  v_mfma_f32_32x32x16_f16 v[24:39], v[230:233], v[210:213], v[24:39]
  v_perm_b32 v203, v108, v106, s12
  v_pk_mul_f16 v203, v203, v203
  v_perm_b32 v204, v112, v110, s12
  v_pk_mul_f16 v204, v204, v204
  v_mfma_f32_32x32x16_f16 v[150:165], v[226:229], v[210:213], v[150:165]
  v_perm_b32 v205, v116, v114, s12
  v_pk_mul_f16 v205, v205, v205
  s_waitcnt lgkmcnt(0)
  v_mfma_f32_32x32x16_f16 v[118:133], v[214:217], v[198:201], v[118:133]
  v_pk_mul_f16 v206, v100, v195
  v_pk_mul_f16 v207, v102, v195
  v_mfma_f32_32x32x16_f16 v[150:165], v[214:217], v[202:205], v[150:165]
  v_pk_mul_f16 v208, v104, v195
  v_mov_b32 v209, v196
  v_mfma_f32_32x32x16_f16 v[134:149], v[218:221], v[198:201], v[134:149]
  v_pk_mul_f16 v210, v113, v195
  v_pk_mul_f16 v211, v115, v195
  v_pk_mul_f16 v212, v117, v195
  v_mfma_f32_32x32x16_f16 v[24:39], v[218:221], v[202:205], v[24:39]
  v_mov_b32 v213, v196
  s_nop 0
  v_ldexp_f32 v118, v118, v66
  v_ldexp_f32 v119, v119, v67
  v_ldexp_f32 v120, v120, v68
  v_ldexp_f32 v121, v121, v69
  v_ldexp_f32 v122, v122, v70
  v_ldexp_f32 v123, v123, v71
  v_ldexp_f32 v124, v124, v72
  v_ldexp_f32 v125, v125, v73
  v_ldexp_f32 v126, v126, v74
  v_ldexp_f32 v127, v127, v75
  v_ldexp_f32 v128, v128, v76
  v_ldexp_f32 v129, v129, v77
  v_ldexp_f32 v130, v130, v78
  v_mfma_f32_32x32x16_f16 v[134:149], v[238:241], v[206:209], v[134:149]
  v_ldexp_f32 v150, v150, v66
  v_ldexp_f32 v151, v151, v67
  v_ldexp_f32 v152, v152, v68
  v_ldexp_f32 v153, v153, v69
  v_ldexp_f32 v154, v154, v70
  v_ldexp_f32 v155, v155, v71
  v_ldexp_f32 v156, v156, v72
  v_ldexp_f32 v157, v157, v73
  v_ldexp_f32 v158, v158, v74
  v_ldexp_f32 v159, v159, v75
  v_ldexp_f32 v160, v160, v76
  v_ldexp_f32 v161, v161, v77
  v_ldexp_f32 v162, v162, v78
  v_mfma_f32_32x32x16_f16 v[24:39], v[238:241], v[210:213], v[24:39]
  s_cmp_lt_u32 s10, 4
  s_cbranch_scc1 L_C_slow
L_C_fin:
  v_add_f32 v182, v182, v10
  v_add_f32 v183, v183, v11
  v_add_f32 v184, v184, v12
  v_add_f32 v185, v185, v13
  v_fmac_f32 v182, v118, v134
  v_fmac_f32 v183, v119, v135
  v_fmac_f32 v184, v120, v136
  v_fmac_f32 v185, v121, v137
  v_fmac_f32 v182, v122, v138
  v_fmac_f32 v183, v123, v139
  v_fmac_f32 v184, v124, v140
  v_fmac_f32 v185, v125, v141
  v_fmac_f32 v182, v126, v142
  v_fmac_f32 v183, v127, v143
  v_fmac_f32 v184, v128, v144
  v_fmac_f32 v185, v129, v145
  v_fmac_f32 v182, v130, v146
  v_fmac_f32 v182, v150, v24
  v_fmac_f32 v183, v151, v25
  v_fmac_f32 v184, v152, v26
  v_fmac_f32 v185, v153, v27
  v_fmac_f32 v182, v154, v28
  v_fmac_f32 v183, v155, v29
  v_fmac_f32 v184, v156, v30
  v_fmac_f32 v185, v157, v31
  v_fmac_f32 v182, v158, v32
  v_fmac_f32 v183, v159, v33
  v_fmac_f32 v184, v160, v34
  v_fmac_f32 v185, v161, v35
  v_fmac_f32 v182, v162, v36
  v_add_f32 v182, v182, v183
  v_add_f32 v184, v184, v185
  v_add_f32 v182, v182, v184
  v_mov_b32 v183, v182
  s_nop 1
  v_permlane32_swap_b32 v182, v183
  v_add_f32 v182, v182, v183
  v_mov_b32 v183, v182
  s_nop 1
  v_permlane16_swap_b32 v182, v183
  v_add_f32 v182, v182, v183
  v_cvt_pk_bf16_f32 v182, v182, v182
  s_mov_b64 exec, 0xffff
  buffer_store_short v182, v5, s[56:59], s13 offen
  s_endpgm
L_C_slow:
  s_setprio 0
  s_branch L_C_w3_in
L_C_w3:
  s_sleep 1
L_C_w3_in:
  ds_read_b32 v195, v2 offset:4
  s_waitcnt lgkmcnt(0)
  v_readfirstlane_b32 s5, v195
  s_cmp_lt_u32 s5, 4
  s_cbranch_scc1 L_C_w3
  ds_read_b32 v10, v8
  ds_read_b32 v11, v8 offset:14336
  ds_read_b32 v12, v8 offset:28672
  ds_read_b32 v13, v8 offset:43008
  s_waitcnt lgkmcnt(0)
  s_branch L_C_fin
L_C_notyet:
  s_setprio 0
  s_cmp_lg_u32 s3, 0
  s_cbranch_scc1 L_C_w0
  s_mov_b32 s14, 131072
L_C_poll:
  s_sleep 6
  buffer_load_dword v194, v5, s[60:63], 0 offen sc1
  s_waitcnt vmcnt(0)
  v_readfirstlane_b32 s5, v194
  s_sub_u32 s14, s14, 1
  s_cmp_eq_u32 s14, 0
  s_cbranch_scc1 L_C_got
  s_cmp_lg_u32 s5, 0x3fff
  s_cbranch_scc1 L_C_poll
L_C_got:
  s_setprio 3
  s_branch L_C_ready
L_C_w0s:
  s_sleep 2
L_C_w0:
  ds_read_b32 v190, v2 offset:16
  s_waitcnt lgkmcnt(0)
  v_readfirstlane_b32 s5, v190
  s_cmp_eq_u32 s5, 0
  s_cbranch_scc1 L_C_w0s
  s_branch L_C_got
L_P2u:
  s_mov_b32 s54, 42336
  s_mov_b32 s55, 0x20000
  s_mov_b32 s58, 32768
  s_mov_b32 s59, 0x20000
  s_mov_b64 s[52:53], s[36:37]
  s_mov_b64 s[56:57], s[32:33]
  v_mov_b32 v2, 142336
  v_mov_b32 v24, 0
  v_mov_b32 v25, 0
  v_mov_b32 v26, 0
  v_mov_b32 v27, 0
  ds_write_b128 v2, v[24:27]
  ds_write_b32 v2, v24 offset:16
  v_mov_b32 v5, 0
  v_mov_b32 v6, 1
  v_mov_b32 v11, 65536
  s_mov_b64 exec, 1
  global_load_ushort v250, v5, s[30:31]
  s_mov_b64 exec, -1
  v_and_b32 v8, 15, v1
  v_mul_u32_u24 v7, 104, v8
  v_add_u32 v7, s13, v7
  v_lshrrev_b32 v9, 2, v1
  v_xor_b32 v9, v9, v1
  v_and_b32 v9, 8, v9
  v_and_b32 v10, 16, v1
  v_add_u32 v4, v9, v10
  s_lshl_b32 s5, s3, 10
  s_add_u32 s92, s5, 144512
  v_add_u32 v41, s92, v32
  ds_write_b128 v41, v[24:27]
  v_add_u32 v42, s90, v32
  ds_write_b128 v42, v[24:27] offset:9216
  ds_write_b128 v42, v[24:27] offset:10240
  s_mov_b64 exec, 0xffffff
  v_add_u32 v42, 144064, v32
  ds_write_b128 v42, v[24:27]
  s_mov_b64 exec, -1
  v_lshlrev_b32 v43, 6, v29
  v_add_u32 v43, 142400, v43
  ds_write_b64 v43, v[24:25] offset:56
  v_and_b32 v36, 1, v29
  v_lshlrev_b32 v36, 4, v36
  v_mov_b32 v37, 0x3f80
  v_lshlrev_b32 v37, v36, v37
  v_cmp_gt_u32 vcc, 26, v29
  v_lshrrev_b32 v38, 1, v29
  v_lshlrev_b32 v39, 2, v30
  v_cndmask_b32 v37, 0, v37, vcc
  v_sub_u32 v39, v38, v39
  v_lshlrev_b32 v40, 1, v30
  v_sub_u32 v40, v38, v40
  v_cmp_eq_u32 vcc, 0, v39
  v_cmp_eq_u32 s[96:97], 1, v39
  s_nop 0
  v_cndmask_b32 v164, 0, v37, vcc
  v_cndmask_b32 v165, 0, v37, s[96:97]
  v_cmp_eq_u32 vcc, 2, v39
  v_cmp_eq_u32 s[96:97], 3, v39
  s_nop 0
  v_cndmask_b32 v166, 0, v37, vcc
  v_cndmask_b32 v167, 0, v37, s[96:97]
  v_cmp_eq_u32 vcc, 8, v39
  v_cmp_eq_u32 s[96:97], 9, v39
  s_nop 0
  v_cndmask_b32 v168, 0, v37, vcc
  v_cndmask_b32 v169, 0, v37, s[96:97]
  v_cmp_eq_u32 vcc, 10, v39
  v_cmp_eq_u32 s[96:97], 11, v39
  s_nop 0
  v_cndmask_b32 v170, 0, v37, vcc
  v_cndmask_b32 v171, 0, v37, s[96:97]
  s_mul_i32 s93, s39, 784
  s_add_u32 s93, s93, 21168
  v_mov_b32 v36, s92
  v_lshrrev_b32 v38, 4, v1
  v_bfe_u32 v39, v1, 2, 2
  v_lshl_add_u32 v38, v38, 3, v39
  v_mul_u32_u24 v38, 352, v38
  v_and_b32 v40, 3, v1
  v_lshl_add_u32 v38, v40, 3, v38
  v_add_u32 v28, s90, v38
  v_lshl_add_u32 v39, v30, 2, v39
  v_lshlrev_b32 v39, 6, v39
  v_lshl_add_u32 v39, v40, 3, v39
  v_and_b32 v40, 16, v1
  v_lshl_add_u32 v39, v40, 1, v39
  v_add_u32 v42, 142400, v39
  s_mul_i32 s5, s3, 176
  v_add_u32 v38, s5, v1
  v_mov_b32 v43, 142400
  v_mul_u32_u24 v39, 2521, v38
  v_lshrrev_b32 v39, 16, v39
  v_mad_u32_u24 v39, v39, 12, v43
  v_lshl_add_u32 v236, v38, 1, v39
  v_add_u32 v38, 64, v38
  v_mul_u32_u24 v39, 2521, v38
  v_lshrrev_b32 v39, 16, v39
  v_mad_u32_u24 v39, v39, 12, v43
  v_lshl_add_u32 v237, v38, 1, v39
  v_add_u32 v38, 64, v38
  v_mul_u32_u24 v39, 2521, v38
  v_lshrrev_b32 v39, 16, v39
  v_mad_u32_u24 v39, v39, 12, v43
  v_lshl_add_u32 v238, v38, 1, v39
  v_cmp_gt_u32 vcc, 676, v38
  s_and_b32 s15, vcc_hi, 0xffff
  s_mov_b32 s14, vcc_lo
  v_lshl_add_u32 v43, v29, 6, v43
  v_add_u32 v22, 256, v1
  v_mul_u32_u24 v20, 2979, v22
  s_add_u32 m0, s90, 4096
  v_lshrrev_b32 v20, 16, v20
  v_mul_u32_u24 v20, 1000, v20
  v_lshl_add_u32 v116, v22, 4, v20
  buffer_load_dwordx4 v116, s[40:43], s91 offen lds
  v_add_u32 v22, 320, v1
  v_mul_u32_u24 v20, 2979, v22
  s_add_u32 m0, s90, 5120
  v_lshrrev_b32 v20, 16, v20
  v_mul_u32_u24 v20, 1000, v20
  v_lshl_add_u32 v117, v22, 4, v20
  buffer_load_dwordx4 v117, s[40:43], s91 offen lds
  v_add_u32 v22, 384, v1
  v_mul_u32_u24 v20, 2979, v22
  s_add_u32 m0, s90, 6144
  v_lshrrev_b32 v20, 16, v20
  v_mul_u32_u24 v20, 1000, v20
  v_lshl_add_u32 v118, v22, 4, v20
  buffer_load_dwordx4 v118, s[40:43], s91 offen lds
  v_add_u32 v22, 448, v1
  v_mul_u32_u24 v20, 2979, v22
  s_add_u32 m0, s90, 7168
  v_lshrrev_b32 v20, 16, v20
  v_mul_u32_u24 v20, 1000, v20
  v_lshl_add_u32 v119, v22, 4, v20
  buffer_load_dwordx4 v119, s[40:43], s91 offen lds
  v_add_u32 v22, 512, v1
  v_mul_u32_u24 v20, 2979, v22
  s_add_u32 m0, s90, 8192
  v_lshrrev_b32 v20, 16, v20
  v_mul_u32_u24 v20, 1000, v20
  v_lshl_add_u32 v120, v22, 4, v20
  buffer_load_dwordx4 v120, s[40:43], s91 offen lds
  s_waitcnt lgkmcnt(0)
  s_barrier
  s_waitcnt vmcnt(16)
  v_mfma_f32_32x32x16_bf16 v[180:195], v[140:143], v[164:167], 0
  s_waitcnt vmcnt(15)
  v_mfma_f32_32x32x16_bf16 v[180:195], v[144:147], v[168:171], v[180:195]
  s_waitcnt vmcnt(14)
  v_add_u32_sdwa v220, v36, v148 dst_sel:DWORD dst_unused:UNUSED_PAD src0_sel:DWORD src1_sel:WORD_0
  v_add_u32_sdwa v221, v36, v148 dst_sel:DWORD dst_unused:UNUSED_PAD src0_sel:DWORD src1_sel:WORD_1
  v_add_u32_sdwa v222, v36, v149 dst_sel:DWORD dst_unused:UNUSED_PAD src0_sel:DWORD src1_sel:WORD_0
  v_add_u32_sdwa v223, v36, v149 dst_sel:DWORD dst_unused:UNUSED_PAD src0_sel:DWORD src1_sel:WORD_1
  v_add_u32_sdwa v224, v36, v150 dst_sel:DWORD dst_unused:UNUSED_PAD src0_sel:DWORD src1_sel:WORD_0
  v_add_u32_sdwa v225, v36, v150 dst_sel:DWORD dst_unused:UNUSED_PAD src0_sel:DWORD src1_sel:WORD_1
  v_add_u32_sdwa v226, v36, v151 dst_sel:DWORD dst_unused:UNUSED_PAD src0_sel:DWORD src1_sel:WORD_0
  v_add_u32_sdwa v227, v36, v151 dst_sel:DWORD dst_unused:UNUSED_PAD src0_sel:DWORD src1_sel:WORD_1
  s_waitcnt vmcnt(13)
  v_add_u32_sdwa v228, v36, v152 dst_sel:DWORD dst_unused:UNUSED_PAD src0_sel:DWORD src1_sel:WORD_0
  v_add_u32_sdwa v229, v36, v152 dst_sel:DWORD dst_unused:UNUSED_PAD src0_sel:DWORD src1_sel:WORD_1
  v_add_u32_sdwa v230, v36, v153 dst_sel:DWORD dst_unused:UNUSED_PAD src0_sel:DWORD src1_sel:WORD_0
  v_add_u32_sdwa v231, v36, v153 dst_sel:DWORD dst_unused:UNUSED_PAD src0_sel:DWORD src1_sel:WORD_1
  v_add_u32_sdwa v232, v36, v154 dst_sel:DWORD dst_unused:UNUSED_PAD src0_sel:DWORD src1_sel:WORD_0
  v_add_u32_sdwa v233, v36, v154 dst_sel:DWORD dst_unused:UNUSED_PAD src0_sel:DWORD src1_sel:WORD_1
  v_add_u32_sdwa v234, v36, v155 dst_sel:DWORD dst_unused:UNUSED_PAD src0_sel:DWORD src1_sel:WORD_0
  v_cvt_pk_bf16_f32 v196, v180, v181
  v_cvt_pk_bf16_f32 v197, v182, v183
  v_cvt_pk_bf16_f32 v198, v184, v185
  v_cvt_pk_bf16_f32 v199, v186, v187
  v_cvt_pk_bf16_f32 v200, v188, v189
  v_cvt_pk_bf16_f32 v201, v190, v191
  v_cvt_pk_bf16_f32 v202, v192, v193
  v_cvt_pk_bf16_f32 v203, v194, v195
  v_add_u32 v11, s13, v32
  v_and_b32 v9, 8, v12
  v_lshlrev_b32 v12, 5, v12
  v_lshl_or_b32 v12, v9, 1, v12
  v_and_b32 v8, 8, v13
  v_lshlrev_b32 v13, 5, v13
  v_lshl_or_b32 v13, v8, 1, v13
  v_and_b32 v9, 8, v14
  v_lshlrev_b32 v14, 5, v14
  v_lshl_or_b32 v14, v9, 1, v14
  v_and_b32 v8, 8, v15
  v_lshlrev_b32 v15, 5, v15
  v_lshl_or_b32 v15, v8, 1, v15
  ds_write_b128 v11, v[12:15]
  v_and_b32 v9, 8, v16
  v_lshlrev_b32 v16, 5, v16
  v_lshl_or_b32 v16, v9, 1, v16
  v_and_b32 v8, 8, v17
  v_lshlrev_b32 v17, 5, v17
  v_lshl_or_b32 v17, v8, 1, v17
  v_and_b32 v9, 8, v18
  v_lshlrev_b32 v18, 5, v18
  v_lshl_or_b32 v18, v9, 1, v18
  v_and_b32 v8, 8, v19
  v_lshlrev_b32 v19, 5, v19
  v_lshl_or_b32 v19, v8, 1, v19
  ds_write_b128 v11, v[16:19] offset:640
  s_mov_b64 exec, 0x3ffffff
  s_waitcnt vmcnt(10)
  ds_write_b32 v43, v34 offset:52
  s_mov_b64 exec, -1
  s_waitcnt vmcnt(9)
  v_lshlrev_b32 v35, 16, v35
  s_mov_b32 s10, 0xf000f
  s_mov_b32 s11, s10
  v_cndmask_b32 v108, 0, v44, s[10:11]
  v_cndmask_b32 v109, 0, v45, s[10:11]
  v_cndmask_b32 v110, 0, v46, s[10:11]
  v_cndmask_b32 v111, 0, v47, s[10:11]
  s_mov_b32 s10, 0xf000f0
  s_mov_b32 s11, s10
  v_cndmask_b32 v112, 0, v44, s[10:11]
  v_cndmask_b32 v113, 0, v45, s[10:11]
  v_cndmask_b32 v114, 0, v46, s[10:11]
  v_cndmask_b32 v115, 0, v47, s[10:11]
  s_mov_b32 s10, 0xf000f00
  s_mov_b32 s11, s10
  v_cndmask_b32 v116, 0, v44, s[10:11]
  v_cndmask_b32 v117, 0, v45, s[10:11]
  v_cndmask_b32 v118, 0, v46, s[10:11]
  v_cndmask_b32 v119, 0, v47, s[10:11]
  s_mov_b32 s10, 0xf000f000
  s_mov_b32 s11, s10
  v_cndmask_b32 v120, 0, v44, s[10:11]
  v_cndmask_b32 v121, 0, v45, s[10:11]
  v_cndmask_b32 v122, 0, v46, s[10:11]
  v_cndmask_b32 v123, 0, v47, s[10:11]
  s_waitcnt vmcnt(0)
  ds_read_b64_tr_b16 v[48:49], v28
  ds_read_b64_tr_b16 v[50:51], v28 offset:1408
  ds_read_b64_tr_b16 v[52:53], v28 offset:32
  ds_read_b64_tr_b16 v[54:55], v28 offset:1440
  ds_read_b64_tr_b16 v[56:57], v28 offset:64
  ds_read_b64_tr_b16 v[58:59], v28 offset:1472
  ds_read_b64_tr_b16 v[60:61], v28 offset:96
  ds_read_b64_tr_b16 v[62:63], v28 offset:1504
  ds_read_b64_tr_b16 v[64:65], v28 offset:128
  ds_read_b64_tr_b16 v[66:67], v28 offset:1536
  ds_read_b64_tr_b16 v[68:69], v28 offset:160
  ds_read_b64_tr_b16 v[70:71], v28 offset:1568
  ds_read_b64_tr_b16 v[72:73], v28 offset:192
  ds_read_b64_tr_b16 v[74:75], v28 offset:1600
  ds_read_b64_tr_b16 v[76:77], v28 offset:224
  ds_read_b64_tr_b16 v[78:79], v28 offset:1632
  ds_read_b64_tr_b16 v[80:81], v28 offset:256
  ds_read_b64_tr_b16 v[82:83], v28 offset:1664
  ds_read_b64_tr_b16 v[84:85], v28 offset:288
  ds_read_b64_tr_b16 v[86:87], v28 offset:1696
  ds_read_b64_tr_b16 v[88:89], v28 offset:320
  ds_read_b64_tr_b16 v[90:91], v28 offset:1728
  s_waitcnt lgkmcnt(15)
  v_mfma_f32_16x16x32_bf16 v[92:95], v[108:111], v[48:51], 0
  v_mfma_f32_16x16x32_bf16 v[92:95], v[112:115], v[52:55], v[92:95]
  v_mfma_f32_16x16x32_bf16 v[92:95], v[116:119], v[56:59], v[92:95]
  s_waitcnt lgkmcnt(14)
  v_mfma_f32_16x16x32_bf16 v[92:95], v[120:123], v[60:63], v[92:95]
  s_waitcnt lgkmcnt(12)
  v_mfma_f32_16x16x32_bf16 v[96:99], v[108:111], v[64:67], 0
  s_waitcnt lgkmcnt(10)
  v_mfma_f32_16x16x32_bf16 v[96:99], v[112:115], v[68:71], v[96:99]
  s_waitcnt lgkmcnt(8)
  v_mfma_f32_16x16x32_bf16 v[96:99], v[116:119], v[72:75], v[96:99]
  s_waitcnt lgkmcnt(6)
  v_mfma_f32_16x16x32_bf16 v[96:99], v[120:123], v[76:79], v[96:99]
  s_waitcnt lgkmcnt(4)
  v_mfma_f32_16x16x32_bf16 v[100:103], v[108:111], v[80:83], 0
  s_waitcnt lgkmcnt(2)
  v_mfma_f32_16x16x32_bf16 v[100:103], v[112:115], v[84:87], v[100:103]
  s_waitcnt lgkmcnt(0)
  v_mfma_f32_16x16x32_bf16 v[100:103], v[116:119], v[88:91], v[100:103]
  v_cvt_pk_bf16_f32 v92, v92, v92
  ds_write_b16 v236, v92
  v_cvt_pk_bf16_f32 v96, v96, v96
  ds_write_b16 v237, v96
  s_nop 3
  v_cvt_pk_bf16_f32 v100, v100, v100
  s_mov_b64 exec, s[14:15]
  ds_write_b16 v238, v100
  s_mov_b64 exec, 1
  ds_add_u32 v2, v6 offset:8
  s_mov_b64 exec, -1
L_P_wm:
  ds_read_b32 v44, v2 offset:8
  s_waitcnt lgkmcnt(0)
  v_readfirstlane_b32 s5, v44
  s_cmp_lt_u32 s5, 4
  s_cbranch_scc1 L_P_wm
  ds_read_b64_tr_b16 v[172:173], v42
  ds_read_b64_tr_b16 v[174:175], v42 offset:512
  ds_read_b64_tr_b16 v[176:177], v42 offset:1024
  ds_read_b64_tr_b16 v[178:179], v42 offset:1536
  s_waitcnt lgkmcnt(2)
  v_mfma_f32_32x32x16_bf16 v[204:219], v[196:199], v[172:175], 0
  s_waitcnt lgkmcnt(0)
  v_mfma_f32_32x32x16_bf16 v[204:219], v[200:203], v[176:179], v[204:219]
  v_mfma_f32_32x32x16_bf16 v[204:219], v[172:175], v[196:199], v[204:219]
  v_mfma_f32_32x32x16_bf16 v[204:219], v[176:179], v[200:203], v[204:219]
  s_nop 11
  v_mov_b32 v218, v35
  v_max3_f32 v44, |v204|, |v205|, |v218|
  v_max3_f32 v45, |v206|, |v207|, |v208|
  v_max3_f32 v44, |v209|, |v210|, v44
  v_max3_f32 v45, |v211|, |v212|, v45
  v_max3_f32 v44, |v213|, |v214|, v44
  v_max3_f32 v45, |v215|, |v216|, v45
  v_max3_f32 v44, |v217|, v45, v44
  s_nop 1
  v_max_f32_dpp v44, v44, v44 row_ror:8 row_mask:0xf bank_mask:0xf
  s_nop 1
  v_max_f32_dpp v44, v44, v44 row_ror:4 row_mask:0xf bank_mask:0xf
  s_nop 1
  v_max_f32_dpp v44, v44, v44 row_ror:2 row_mask:0xf bank_mask:0xf
  s_nop 1
  v_max_f32_dpp v44, v44, v44 row_ror:1 row_mask:0xf bank_mask:0xf
  s_nop 0
  v_readlane_b32 s8, v44, 0
  v_readlane_b32 s9, v44, 16
  v_readlane_b32 s10, v44, 32
  v_readlane_b32 s11, v44, 48
  s_max_u32 s8, s8, s9
  s_max_u32 s10, s10, s11
  s_max_u32 s8, s8, s10
  s_lshr_b32 s8, s8, 23
  s_max_u32 s8, s8, 67
  s_min_u32 s8, s8, 187
  s_sub_u32 s9, 268, s8
  s_lshl_b32 s9, s9, 23
  s_cmp_ge_u32 s39, 26
  s_cselect_b32 s9, 0, s9
  v_mul_f32 v204, s9, v204
  v_mul_f32 v205, s9, v205
  v_mul_f32 v206, s9, v206
  v_mul_f32 v207, s9, v207
  v_mul_f32 v208, s9, v208
  v_mul_f32 v209, s9, v209
  v_mul_f32 v210, s9, v210
  v_mul_f32 v211, s9, v211
  v_mul_f32 v212, s9, v212
  v_mul_f32 v213, s9, v213
  v_mul_f32 v214, s9, v214
  v_mul_f32 v215, s9, v215
  v_mul_f32 v216, s9, v216
  v_mul_f32 v217, s9, v217
  v_mul_f32 v218, s9, v218
  v_cvt_pk_f16_f32 v204, v204, v205
  v_cvt_pk_f16_f32 v206, v206, v207
  v_cvt_pk_f16_f32 v208, v208, v209
  v_cvt_pk_f16_f32 v210, v210, v211
  v_cvt_pk_f16_f32 v212, v212, v213
  v_cvt_pk_f16_f32 v214, v214, v215
  v_cvt_pk_f16_f32 v216, v216, v217
  v_cvt_pk_f16_f32 v218, v218, v218
  ds_write_b16 v220, v204
  ds_write_b16_d16_hi v221, v204
  ds_write_b16 v222, v206
  ds_write_b16_d16_hi v223, v206
  ds_write_b16 v224, v208
  ds_write_b16_d16_hi v225, v208
  ds_write_b16 v226, v210
  ds_write_b16_d16_hi v227, v210
  ds_write_b16 v228, v212
  ds_write_b16_d16_hi v229, v212
  ds_write_b16 v230, v214
  ds_write_b16_d16_hi v231, v214
  ds_write_b16 v232, v216
  ds_write_b16_d16_hi v233, v216
  ds_write_b16 v234, v218
  ds_read_b128 v[240:243], v41
  s_waitcnt lgkmcnt(0)
  v_pk_mul_f16 v240, v240, v156
  v_pk_mul_f16 v241, v241, v157
  v_pk_mul_f16 v242, v242, v158
  v_pk_mul_f16 v243, v243, v159
  s_cmp_ge_u32 s39, 27
  v_writelane_b32 v240, s8, 48
  s_cbranch_scc1 L_P_skipu
  s_mov_b32 exec_hi, 0x1ffff
  buffer_store_dwordx4 v[240:243], v32, s[52:55], s93 offen sc1
  s_mov_b32 exec_hi, -1
L_P_skipu:
  s_mov_b32 s38, 1
  s_mov_b32 s91, 1
  s_lshr_b32 s5, s2, 3
  s_lshl_b32 s90, 1, s5
  s_waitcnt lgkmcnt(0)
  s_barrier
  s_setprio 0
  s_branch L_C_join
L_P2x:
  s_mov_b32 s54, 42336
  s_mov_b32 s55, 0x20000
  s_mov_b32 s58, 32768
  s_mov_b32 s59, 0x20000
  s_mov_b64 s[52:53], s[36:37]
  s_mov_b64 s[56:57], s[32:33]
  v_mov_b32 v2, 142336
  v_mov_b32 v24, 0
  v_mov_b32 v25, 0
  v_mov_b32 v26, 0
  v_mov_b32 v27, 0
  ds_write_b128 v2, v[24:27]
  ds_write_b32 v2, v24 offset:16
  v_mov_b32 v5, 0
  v_mov_b32 v6, 1
  v_mov_b32 v11, 65536
  s_mov_b64 exec, 1
  global_load_ushort v250, v5, s[30:31]
  s_mov_b64 exec, -1
  v_and_b32 v8, 15, v1
  v_mul_u32_u24 v7, 104, v8
  v_add_u32 v7, s13, v7
  v_lshrrev_b32 v9, 2, v1
  v_xor_b32 v9, v9, v1
  v_and_b32 v9, 8, v9
  v_and_b32 v10, 16, v1
  v_add_u32 v4, v9, v10
  s_lshl_b32 s5, s3, 10
  s_add_u32 s92, s5, 144512
  v_add_u32 v41, s92, v32
  ds_write_b128 v41, v[24:27]
  v_and_b32 v36, 1, v29
  v_lshlrev_b32 v36, 4, v36
  v_mov_b32 v37, 0x3f80
  v_lshlrev_b32 v37, v36, v37
  v_cmp_gt_u32 vcc, 26, v29
  v_lshrrev_b32 v38, 1, v29
  v_lshlrev_b32 v39, 2, v30
  v_cndmask_b32 v37, 0, v37, vcc
  v_sub_u32 v39, v38, v39
  v_lshlrev_b32 v40, 1, v30
  v_sub_u32 v40, v38, v40
  v_cmp_eq_u32 vcc, 0, v39
  v_cmp_eq_u32 s[96:97], 1, v39
  s_nop 0
  v_cndmask_b32 v164, 0, v37, vcc
  v_cndmask_b32 v165, 0, v37, s[96:97]
  v_cmp_eq_u32 vcc, 2, v39
  v_cmp_eq_u32 s[96:97], 3, v39
  s_nop 0
  v_cndmask_b32 v166, 0, v37, vcc
  v_cndmask_b32 v167, 0, v37, s[96:97]
  v_cmp_eq_u32 vcc, 8, v39
  v_cmp_eq_u32 s[96:97], 9, v39
  s_nop 0
  v_cndmask_b32 v168, 0, v37, vcc
  v_cndmask_b32 v169, 0, v37, s[96:97]
  v_cmp_eq_u32 vcc, 10, v39
  v_cmp_eq_u32 s[96:97], 11, v39
  s_nop 0
  v_cndmask_b32 v170, 0, v37, vcc
  v_cndmask_b32 v171, 0, v37, s[96:97]
  v_cmp_eq_u32 vcc, 0, v40
  v_cmp_eq_u32 s[96:97], 1, v40
  s_nop 0
  v_cndmask_b32 v172, 0, v37, vcc
  v_cndmask_b32 v173, 0, v37, s[96:97]
  v_cmp_eq_u32 vcc, 4, v40
  v_cmp_eq_u32 s[96:97], 5, v40
  s_nop 0
  v_cndmask_b32 v174, 0, v37, vcc
  v_cndmask_b32 v175, 0, v37, s[96:97]
  v_cmp_eq_u32 vcc, 8, v40
  v_cmp_eq_u32 s[96:97], 9, v40
  s_nop 0
  v_cndmask_b32 v176, 0, v37, vcc
  v_cndmask_b32 v177, 0, v37, s[96:97]
  v_cmp_eq_u32 vcc, 12, v40
  v_cmp_eq_u32 s[96:97], 13, v40
  s_nop 0
  v_cndmask_b32 v178, 0, v37, vcc
  v_cndmask_b32 v179, 0, v37, s[96:97]
  s_mul_i32 s93, s39, 784
  v_mov_b32 v36, s92
  s_waitcnt vmcnt(4)
  v_mfma_f32_32x32x16_bf16 v[180:195], v[140:143], v[164:167], 0
  s_waitcnt vmcnt(3)
  v_mfma_f32_32x32x16_bf16 v[180:195], v[144:147], v[168:171], v[180:195]
  s_waitcnt vmcnt(2)
  v_add_u32_sdwa v220, v36, v148 dst_sel:DWORD dst_unused:UNUSED_PAD src0_sel:DWORD src1_sel:WORD_0
  v_add_u32_sdwa v221, v36, v148 dst_sel:DWORD dst_unused:UNUSED_PAD src0_sel:DWORD src1_sel:WORD_1
  v_add_u32_sdwa v222, v36, v149 dst_sel:DWORD dst_unused:UNUSED_PAD src0_sel:DWORD src1_sel:WORD_0
  v_add_u32_sdwa v223, v36, v149 dst_sel:DWORD dst_unused:UNUSED_PAD src0_sel:DWORD src1_sel:WORD_1
  v_add_u32_sdwa v224, v36, v150 dst_sel:DWORD dst_unused:UNUSED_PAD src0_sel:DWORD src1_sel:WORD_0
  v_add_u32_sdwa v225, v36, v150 dst_sel:DWORD dst_unused:UNUSED_PAD src0_sel:DWORD src1_sel:WORD_1
  v_add_u32_sdwa v226, v36, v151 dst_sel:DWORD dst_unused:UNUSED_PAD src0_sel:DWORD src1_sel:WORD_0
  v_add_u32_sdwa v227, v36, v151 dst_sel:DWORD dst_unused:UNUSED_PAD src0_sel:DWORD src1_sel:WORD_1
  s_waitcnt vmcnt(1)
  v_add_u32_sdwa v228, v36, v152 dst_sel:DWORD dst_unused:UNUSED_PAD src0_sel:DWORD src1_sel:WORD_0
  v_add_u32_sdwa v229, v36, v152 dst_sel:DWORD dst_unused:UNUSED_PAD src0_sel:DWORD src1_sel:WORD_1
  v_add_u32_sdwa v230, v36, v153 dst_sel:DWORD dst_unused:UNUSED_PAD src0_sel:DWORD src1_sel:WORD_0
  v_add_u32_sdwa v231, v36, v153 dst_sel:DWORD dst_unused:UNUSED_PAD src0_sel:DWORD src1_sel:WORD_1
  v_add_u32_sdwa v232, v36, v154 dst_sel:DWORD dst_unused:UNUSED_PAD src0_sel:DWORD src1_sel:WORD_0
  v_add_u32_sdwa v233, v36, v154 dst_sel:DWORD dst_unused:UNUSED_PAD src0_sel:DWORD src1_sel:WORD_1
  v_add_u32_sdwa v234, v36, v155 dst_sel:DWORD dst_unused:UNUSED_PAD src0_sel:DWORD src1_sel:WORD_0
  v_cvt_pk_bf16_f32 v196, v180, v181
  v_cvt_pk_bf16_f32 v197, v182, v183
  v_cvt_pk_bf16_f32 v198, v184, v185
  v_cvt_pk_bf16_f32 v199, v186, v187
  v_cvt_pk_bf16_f32 v200, v188, v189
  v_cvt_pk_bf16_f32 v201, v190, v191
  v_cvt_pk_bf16_f32 v202, v192, v193
  v_cvt_pk_bf16_f32 v203, v194, v195
  v_add_u32 v11, s13, v32
  v_and_b32 v9, 8, v12
  v_lshlrev_b32 v12, 5, v12
  v_lshl_or_b32 v12, v9, 1, v12
  v_and_b32 v8, 8, v13
  v_lshlrev_b32 v13, 5, v13
  v_lshl_or_b32 v13, v8, 1, v13
  v_and_b32 v9, 8, v14
  v_lshlrev_b32 v14, 5, v14
  v_lshl_or_b32 v14, v9, 1, v14
  v_and_b32 v8, 8, v15
  v_lshlrev_b32 v15, 5, v15
  v_lshl_or_b32 v15, v8, 1, v15
  ds_write_b128 v11, v[12:15]
  v_and_b32 v9, 8, v16
  v_lshlrev_b32 v16, 5, v16
  v_lshl_or_b32 v16, v9, 1, v16
  v_and_b32 v8, 8, v17
  v_lshlrev_b32 v17, 5, v17
  v_lshl_or_b32 v17, v8, 1, v17
  v_and_b32 v9, 8, v18
  v_lshlrev_b32 v18, 5, v18
  v_lshl_or_b32 v18, v9, 1, v18
  v_and_b32 v8, 8, v19
  v_lshlrev_b32 v19, 5, v19
  v_lshl_or_b32 v19, v8, 1, v19
  ds_write_b128 v11, v[16:19] offset:640
  s_waitcnt lgkmcnt(0)
  s_barrier
  v_mfma_f32_32x32x16_bf16 v[204:219], v[196:199], v[172:175], 0
  v_mfma_f32_32x32x16_bf16 v[204:219], v[200:203], v[176:179], v[204:219]
  v_mfma_f32_32x32x16_bf16 v[204:219], v[172:175], v[196:199], v[204:219]
  v_mfma_f32_32x32x16_bf16 v[204:219], v[176:179], v[200:203], v[204:219]
  s_nop 11
  v_max3_f32 v44, |v204|, |v205|, |v217|
  v_max3_f32 v45, |v206|, |v207|, |v208|
  v_max3_f32 v44, |v209|, |v210|, v44
  v_max3_f32 v45, |v211|, |v212|, v45
  v_max3_f32 v44, |v213|, |v214|, v44
  v_max3_f32 v45, |v215|, |v216|, v45
  v_max3_f32 v44, |v217|, v45, v44
  s_nop 1
  v_max_f32_dpp v44, v44, v44 row_ror:8 row_mask:0xf bank_mask:0xf
  s_nop 1
  v_max_f32_dpp v44, v44, v44 row_ror:4 row_mask:0xf bank_mask:0xf
  s_nop 1
  v_max_f32_dpp v44, v44, v44 row_ror:2 row_mask:0xf bank_mask:0xf
  s_nop 1
  v_max_f32_dpp v44, v44, v44 row_ror:1 row_mask:0xf bank_mask:0xf
  s_nop 0
  v_readlane_b32 s8, v44, 0
  v_readlane_b32 s9, v44, 16
  v_readlane_b32 s10, v44, 32
  v_readlane_b32 s11, v44, 48
  s_max_u32 s8, s8, s9
  s_max_u32 s10, s10, s11
  s_max_u32 s8, s8, s10
  s_lshr_b32 s8, s8, 23
  s_max_u32 s8, s8, 67
  s_min_u32 s8, s8, 187
  s_sub_u32 s9, 268, s8
  s_lshl_b32 s9, s9, 23
  s_cmp_ge_u32 s39, 26
  s_cselect_b32 s9, 0, s9
  v_mul_f32 v204, s9, v204
  v_mul_f32 v205, s9, v205
  v_mul_f32 v206, s9, v206
  v_mul_f32 v207, s9, v207
  v_mul_f32 v208, s9, v208
  v_mul_f32 v209, s9, v209
  v_mul_f32 v210, s9, v210
  v_mul_f32 v211, s9, v211
  v_mul_f32 v212, s9, v212
  v_mul_f32 v213, s9, v213
  v_mul_f32 v214, s9, v214
  v_mul_f32 v215, s9, v215
  v_mul_f32 v216, s9, v216
  v_mul_f32 v217, s9, v217
  v_cvt_pk_f16_f32 v204, v204, v205
  v_cvt_pk_f16_f32 v206, v206, v207
  v_cvt_pk_f16_f32 v208, v208, v209
  v_cvt_pk_f16_f32 v210, v210, v211
  v_cvt_pk_f16_f32 v212, v212, v213
  v_cvt_pk_f16_f32 v214, v214, v215
  v_cvt_pk_f16_f32 v216, v216, v217
  ds_write_b16 v220, v204
  ds_write_b16_d16_hi v221, v204
  ds_write_b16 v222, v206
  ds_write_b16_d16_hi v223, v206
  ds_write_b16 v224, v208
  ds_write_b16_d16_hi v225, v208
  ds_write_b16 v226, v210
  ds_write_b16_d16_hi v227, v210
  ds_write_b16 v228, v212
  ds_write_b16_d16_hi v229, v212
  ds_write_b16 v230, v214
  ds_write_b16_d16_hi v231, v214
  ds_write_b16 v232, v216
  ds_write_b16_d16_hi v233, v216
  ds_read_b128 v[240:243], v41
  s_waitcnt vmcnt(0) lgkmcnt(0)
  v_pk_mul_f16 v240, v240, v156
  v_pk_mul_f16 v241, v241, v157
  v_pk_mul_f16 v242, v242, v158
  v_pk_mul_f16 v243, v243, v159
  s_cmp_ge_u32 s39, 27
  v_writelane_b32 v240, s8, 48
  s_cbranch_scc1 L_P_skipx
  s_mov_b32 exec_hi, 0x1ffff
  buffer_store_dwordx4 v[240:243], v32, s[52:55], s93 offen sc1
  s_mov_b32 exec_hi, -1
L_P_skipx:
  s_mov_b32 s38, 1
  s_mov_b32 s91, 1
  s_lshr_b32 s5, s2, 3
  s_lshl_b32 s90, 1, s5
  s_waitcnt lgkmcnt(0)
  s_setprio 0
  s_branch L_C_join
L_D2:
  global_load_dword v15, v9, s[28:29]
  v_lshrrev_b32 v10, 5, v1
  v_bfe_u32 v11, v1, 2, 3
  v_lshl_add_u32 v11, v10, 4, v11
  v_mul_u32_u24 v11, 224, v11
  v_and_b32 v12, 3, v1
  v_lshl_add_u32 v11, v12, 3, v11
  v_add_u32 v9, s7, v11
  s_lshr_b32 s5, s39, 4
  v_xor_b32 v10, s5, v10
  v_and_b32 v11, 15, v1
  v_mul_u32_u24 v11, 104, v11
  v_lshl_add_u32 v11, v10, 2, v11
  s_mul_i32 s5, s14, 3328
  s_sub_u32 s9, 3328, s5
  v_add_u32 v252, s5, v11
  v_add_u32 v253, s9, v11
  v_and_b32 v12, 16, v1
  s_lshl_b32 s10, s4, 3
  s_lshl_b32 s5, s6, 10
  s_add_u32 s5, s5, 148608
  v_lshl_add_u32 v13, v1, 3, s5
  v_and_b32 v10, 48, v1
  v_add_u32 v254, s5, v10
  s_waitcnt vmcnt(16)
  v_lshlrev_b32 v244, 16, v14
  v_and_b32 v245, 0xffff0000, v14
  ds_write_b64 v13, v[244:245]
  ds_read_b128 v[208:211], v254
  ds_read_b128 v[212:215], v254 offset:64
  ds_read_b128 v[216:219], v254 offset:128
  ds_read_b128 v[220:223], v254 offset:192
  ds_read_b128 v[224:227], v254 offset:256
  ds_read_b128 v[228:231], v254 offset:320
  ds_read_b128 v[232:235], v254 offset:384
  v_add_u32 v10, s10, v252
  v_add_u32 v11, s10, v253
  s_add_u32 s10, s10, 8
  s_cmp_eq_u32 s10, 104
  s_cselect_b32 s10, 0, s10
  s_waitcnt vmcnt(4)
  s_barrier
  s_setprio 2
  ds_read_b32 v236, v10 offset:32768
  ds_read_b32 v237, v10 offset:34432
  ds_read_b32 v238, v11 offset:32768
  ds_read_b32 v239, v11 offset:34432
  v_add_u32 v10, s10, v252
  v_add_u32 v11, s10, v253
  s_add_u32 s10, s10, 8
  s_cmp_eq_u32 s10, 104
  s_cselect_b32 s10, 0, s10
  s_waitcnt lgkmcnt(3)
  v_xor_b32 v236, v236, v12
  ds_read_b128 v[176:179], v236
  s_waitcnt lgkmcnt(3)
  v_xor_b32 v237, v237, v12
  ds_read_b128 v[180:183], v237
  s_waitcnt lgkmcnt(3)
  v_xor_b32 v238, v238, v12
  ds_read_b128 v[184:187], v238
  s_waitcnt lgkmcnt(3)
  v_xor_b32 v239, v239, v12
  ds_read_b128 v[188:191], v239
  s_add_u32 m0, s7, 7168
  s_nop 0
  buffer_load_dwordx4 v2, s[40:43], s12 offen lds
  buffer_load_dwordx4 v3, s[40:43], s12 offen offset:1024 lds
  buffer_load_dwordx4 v4, s[40:43], s12 offen offset:2048 lds
  buffer_load_dwordx4 v5, s[40:43], s12 offen offset:3072 lds
  s_add_u32 m0, s7, 11264
  s_nop 0
  buffer_load_dwordx4 v6, s[40:43], s12 offen lds
  buffer_load_dwordx4 v7, s[40:43], s12 offen offset:1024 lds
  buffer_load_dwordx4 v8, s[40:43], s12 offen offset:2048 lds
  s_add_u32 s12, s12, 26624
  s_cmp_eq_u32 s12, 346112
  s_cselect_b32 s12, 0, s12
  s_waitcnt vmcnt(8)
  ds_read_b64_tr_b16 v[120:121], v9
  ds_read_b64_tr_b16 v[122:123], v9 offset:1792
  ds_read_b64_tr_b16 v[124:125], v9 offset:32
  ds_read_b64_tr_b16 v[126:127], v9 offset:1824
  ds_read_b64_tr_b16 v[128:129], v9 offset:64
  ds_read_b64_tr_b16 v[130:131], v9 offset:1856
  ds_read_b64_tr_b16 v[132:133], v9 offset:96
  ds_read_b64_tr_b16 v[134:135], v9 offset:1888
  ds_read_b64_tr_b16 v[136:137], v9 offset:128
  ds_read_b64_tr_b16 v[138:139], v9 offset:1920
  ds_read_b64_tr_b16 v[140:141], v9 offset:160
  ds_read_b64_tr_b16 v[142:143], v9 offset:1952
  ds_read_b64_tr_b16 v[144:145], v9 offset:192
  ds_read_b64_tr_b16 v[146:147], v9 offset:1984
  ds_read_b32 v240, v10 offset:32768
  ds_read_b32 v241, v10 offset:34432
  ds_read_b32 v242, v11 offset:32768
  ds_read_b32 v243, v11 offset:34432
  s_waitcnt lgkmcnt(15)
  v_mfma_f32_16x16x32_bf16 v[16:19], v[120:123], v[176:179], v[208:211]
  s_waitcnt lgkmcnt(4)
  s_add_u32 m0, s7, 0
  v_mfma_f32_16x16x32_bf16 v[32:35], v[124:127], v[176:179], v[212:215]
  s_waitcnt lgkmcnt(3)
  v_xor_b32 v240, v240, v12
  ds_read_b128 v[192:195], v240
  v_mfma_f32_16x16x32_bf16 v[48:51], v[128:131], v[176:179], v[216:219]
  buffer_load_dwordx4 v2, s[40:43], s12 offen lds
  v_mfma_f32_16x16x32_bf16 v[64:67], v[132:135], v[176:179], v[220:223]
  s_waitcnt lgkmcnt(3)
  v_xor_b32 v241, v241, v12
  ds_read_b128 v[196:199], v241
  v_mfma_f32_16x16x32_bf16 v[80:83], v[136:139], v[176:179], v[224:227]
  buffer_load_dwordx4 v3, s[40:43], s12 offen offset:1024 lds
  v_mfma_f32_16x16x32_bf16 v[96:99], v[140:143], v[176:179], v[228:231]
  s_waitcnt lgkmcnt(3)
  v_xor_b32 v242, v242, v12
  ds_read_b128 v[200:203], v242
  v_mfma_f32_16x16x32_bf16 v[112:115], v[144:147], v[176:179], v[232:235]
  buffer_load_dwordx4 v4, s[40:43], s12 offen offset:2048 lds
  v_mfma_f32_16x16x32_bf16 v[20:23], v[120:123], v[180:183], v[208:211]
  s_waitcnt lgkmcnt(3)
  v_xor_b32 v243, v243, v12
  ds_read_b128 v[204:207], v243
  v_mfma_f32_16x16x32_bf16 v[36:39], v[124:127], v[180:183], v[212:215]
  buffer_load_dwordx4 v5, s[40:43], s12 offen offset:3072 lds
  s_add_u32 m0, s7, 4096
  v_mfma_f32_16x16x32_bf16 v[52:55], v[128:131], v[180:183], v[216:219]
  buffer_load_dwordx4 v6, s[40:43], s12 offen lds
  v_mfma_f32_16x16x32_bf16 v[68:71], v[132:135], v[180:183], v[220:223]
  buffer_load_dwordx4 v7, s[40:43], s12 offen offset:1024 lds
  buffer_load_dwordx4 v8, s[40:43], s12 offen offset:2048 lds
  v_mfma_f32_16x16x32_bf16 v[84:87], v[136:139], v[180:183], v[224:227]
  s_waitcnt vmcnt(7)
  ds_read_b64_tr_b16 v[148:149], v9 offset:7168
  ds_read_b64_tr_b16 v[150:151], v9 offset:8960
  v_mfma_f32_16x16x32_bf16 v[100:103], v[140:143], v[180:183], v[228:231]
  ds_read_b64_tr_b16 v[152:153], v9 offset:7200
  ds_read_b64_tr_b16 v[154:155], v9 offset:8992
  v_mfma_f32_16x16x32_bf16 v[116:119], v[144:147], v[180:183], v[232:235]
  ds_read_b64_tr_b16 v[156:157], v9 offset:7232
  ds_read_b64_tr_b16 v[158:159], v9 offset:9024
  v_mfma_f32_16x16x32_bf16 v[24:27], v[120:123], v[184:187], v[208:211]
  ds_read_b64_tr_b16 v[160:161], v9 offset:7264
  ds_read_b64_tr_b16 v[162:163], v9 offset:9056
  v_mfma_f32_16x16x32_bf16 v[40:43], v[124:127], v[184:187], v[212:215]
  ds_read_b64_tr_b16 v[164:165], v9 offset:7296
  ds_read_b64_tr_b16 v[166:167], v9 offset:9088
  v_mfma_f32_16x16x32_bf16 v[56:59], v[128:131], v[184:187], v[216:219]
  ds_read_b64_tr_b16 v[168:169], v9 offset:7328
  ds_read_b64_tr_b16 v[170:171], v9 offset:9120
  v_mfma_f32_16x16x32_bf16 v[72:75], v[132:135], v[184:187], v[220:223]
  ds_read_b64_tr_b16 v[172:173], v9 offset:7360
  ds_read_b64_tr_b16 v[174:175], v9 offset:9152
  v_mfma_f32_16x16x32_bf16 v[88:91], v[136:139], v[184:187], v[224:227]
  v_add_u32 v10, s10, v252
  v_add_u32 v11, s10, v253
  s_add_u32 s10, s10, 8
  s_cmp_eq_u32 s10, 104
  s_cselect_b32 s10, 0, s10
  v_mfma_f32_16x16x32_bf16 v[104:107], v[140:143], v[184:187], v[228:231]
  ds_read_b32 v236, v10 offset:32768
  ds_read_b32 v237, v10 offset:34432
  v_mfma_f32_16x16x32_bf16 v[28:31], v[120:123], v[188:191], v[208:211]
  ds_read_b32 v238, v11 offset:32768
  ds_read_b32 v239, v11 offset:34432
  v_mfma_f32_16x16x32_bf16 v[44:47], v[124:127], v[188:191], v[212:215]
  v_mfma_f32_16x16x32_bf16 v[60:63], v[128:131], v[188:191], v[216:219]
  s_add_u32 s12, s12, 26624
  s_cmp_eq_u32 s12, 346112
  s_cselect_b32 s12, 0, s12
  v_mfma_f32_16x16x32_bf16 v[76:79], v[132:135], v[188:191], v[220:223]
  v_mfma_f32_16x16x32_bf16 v[92:95], v[136:139], v[188:191], v[224:227]
  v_mfma_f32_16x16x32_bf16 v[108:111], v[140:143], v[188:191], v[228:231]
  s_waitcnt lgkmcnt(15)
  v_mfma_f32_16x16x32_bf16 v[16:19], v[148:151], v[192:195], v[16:19]
  s_waitcnt lgkmcnt(4)
  s_add_u32 m0, s7, 7168
  v_mfma_f32_16x16x32_bf16 v[32:35], v[152:155], v[192:195], v[32:35]
  s_waitcnt lgkmcnt(3)
  v_xor_b32 v236, v236, v12
  ds_read_b128 v[176:179], v236
  v_mfma_f32_16x16x32_bf16 v[48:51], v[156:159], v[192:195], v[48:51]
  buffer_load_dwordx4 v2, s[40:43], s12 offen lds
  v_mfma_f32_16x16x32_bf16 v[64:67], v[160:163], v[192:195], v[64:67]
  s_waitcnt lgkmcnt(3)
  v_xor_b32 v237, v237, v12
  ds_read_b128 v[180:183], v237
  v_mfma_f32_16x16x32_bf16 v[80:83], v[164:167], v[192:195], v[80:83]
  buffer_load_dwordx4 v3, s[40:43], s12 offen offset:1024 lds
  v_mfma_f32_16x16x32_bf16 v[96:99], v[168:171], v[192:195], v[96:99]
  s_waitcnt lgkmcnt(3)
  v_xor_b32 v238, v238, v12
  ds_read_b128 v[184:187], v238
  v_mfma_f32_16x16x32_bf16 v[112:115], v[172:175], v[192:195], v[112:115]
  buffer_load_dwordx4 v4, s[40:43], s12 offen offset:2048 lds
  v_mfma_f32_16x16x32_bf16 v[20:23], v[148:151], v[196:199], v[20:23]
  s_waitcnt lgkmcnt(3)
  v_xor_b32 v239, v239, v12
  ds_read_b128 v[188:191], v239
  v_mfma_f32_16x16x32_bf16 v[36:39], v[152:155], v[196:199], v[36:39]
  buffer_load_dwordx4 v5, s[40:43], s12 offen offset:3072 lds
  s_add_u32 m0, s7, 11264
  v_mfma_f32_16x16x32_bf16 v[52:55], v[156:159], v[196:199], v[52:55]
  buffer_load_dwordx4 v6, s[40:43], s12 offen lds
  v_mfma_f32_16x16x32_bf16 v[68:71], v[160:163], v[196:199], v[68:71]
  buffer_load_dwordx4 v7, s[40:43], s12 offen offset:1024 lds
  buffer_load_dwordx4 v8, s[40:43], s12 offen offset:2048 lds
  v_mfma_f32_16x16x32_bf16 v[84:87], v[164:167], v[196:199], v[84:87]
  s_waitcnt vmcnt(7)
  ds_read_b64_tr_b16 v[120:121], v9
  ds_read_b64_tr_b16 v[122:123], v9 offset:1792
  v_mfma_f32_16x16x32_bf16 v[100:103], v[168:171], v[196:199], v[100:103]
  ds_read_b64_tr_b16 v[124:125], v9 offset:32
  ds_read_b64_tr_b16 v[126:127], v9 offset:1824
  v_mfma_f32_16x16x32_bf16 v[116:119], v[172:175], v[196:199], v[116:119]
  ds_read_b64_tr_b16 v[128:129], v9 offset:64
  ds_read_b64_tr_b16 v[130:131], v9 offset:1856
  v_mfma_f32_16x16x32_bf16 v[24:27], v[148:151], v[200:203], v[24:27]
  ds_read_b64_tr_b16 v[132:133], v9 offset:96
  ds_read_b64_tr_b16 v[134:135], v9 offset:1888
  v_mfma_f32_16x16x32_bf16 v[40:43], v[152:155], v[200:203], v[40:43]
  ds_read_b64_tr_b16 v[136:137], v9 offset:128
  ds_read_b64_tr_b16 v[138:139], v9 offset:1920
  v_mfma_f32_16x16x32_bf16 v[56:59], v[156:159], v[200:203], v[56:59]
  ds_read_b64_tr_b16 v[140:141], v9 offset:160
  ds_read_b64_tr_b16 v[142:143], v9 offset:1952
  v_mfma_f32_16x16x32_bf16 v[72:75], v[160:163], v[200:203], v[72:75]
  ds_read_b64_tr_b16 v[144:145], v9 offset:192
  ds_read_b64_tr_b16 v[146:147], v9 offset:1984
  v_mfma_f32_16x16x32_bf16 v[88:91], v[164:167], v[200:203], v[88:91]
  v_add_u32 v10, s10, v252
  v_add_u32 v11, s10, v253
  s_add_u32 s10, s10, 8
  s_cmp_eq_u32 s10, 104
  s_cselect_b32 s10, 0, s10
  v_mfma_f32_16x16x32_bf16 v[104:107], v[168:171], v[200:203], v[104:107]
  ds_read_b32 v240, v10 offset:32768
  ds_read_b32 v241, v10 offset:34432
  v_mfma_f32_16x16x32_bf16 v[28:31], v[148:151], v[204:207], v[28:31]
  ds_read_b32 v242, v11 offset:32768
  ds_read_b32 v243, v11 offset:34432
  v_mfma_f32_16x16x32_bf16 v[44:47], v[152:155], v[204:207], v[44:47]
  v_mfma_f32_16x16x32_bf16 v[60:63], v[156:159], v[204:207], v[60:63]
  s_add_u32 s12, s12, 26624
  s_cmp_eq_u32 s12, 346112
  s_cselect_b32 s12, 0, s12
  v_mfma_f32_16x16x32_bf16 v[76:79], v[160:163], v[204:207], v[76:79]
  v_mfma_f32_16x16x32_bf16 v[92:95], v[164:167], v[204:207], v[92:95]
  v_mfma_f32_16x16x32_bf16 v[108:111], v[168:171], v[204:207], v[108:111]
  s_waitcnt lgkmcnt(15)
  v_mfma_f32_16x16x32_bf16 v[16:19], v[120:123], v[176:179], v[16:19]
  s_waitcnt lgkmcnt(4)
  s_add_u32 m0, s7, 0
  v_mfma_f32_16x16x32_bf16 v[32:35], v[124:127], v[176:179], v[32:35]
  s_waitcnt lgkmcnt(3)
  v_xor_b32 v240, v240, v12
  ds_read_b128 v[192:195], v240
  v_mfma_f32_16x16x32_bf16 v[48:51], v[128:131], v[176:179], v[48:51]
  buffer_load_dwordx4 v2, s[40:43], s12 offen lds
  v_mfma_f32_16x16x32_bf16 v[64:67], v[132:135], v[176:179], v[64:67]
  s_waitcnt lgkmcnt(3)
  v_xor_b32 v241, v241, v12
  ds_read_b128 v[196:199], v241
  v_mfma_f32_16x16x32_bf16 v[80:83], v[136:139], v[176:179], v[80:83]
  buffer_load_dwordx4 v3, s[40:43], s12 offen offset:1024 lds
  v_mfma_f32_16x16x32_bf16 v[96:99], v[140:143], v[176:179], v[96:99]
  s_waitcnt lgkmcnt(3)
  v_xor_b32 v242, v242, v12
  ds_read_b128 v[200:203], v242
  v_mfma_f32_16x16x32_bf16 v[112:115], v[144:147], v[176:179], v[112:115]
  buffer_load_dwordx4 v4, s[40:43], s12 offen offset:2048 lds
  v_mfma_f32_16x16x32_bf16 v[20:23], v[120:123], v[180:183], v[20:23]
  s_waitcnt lgkmcnt(3)
  v_xor_b32 v243, v243, v12
  ds_read_b128 v[204:207], v243
  v_mfma_f32_16x16x32_bf16 v[36:39], v[124:127], v[180:183], v[36:39]
  buffer_load_dwordx4 v5, s[40:43], s12 offen offset:3072 lds
  s_add_u32 m0, s7, 4096
  v_mfma_f32_16x16x32_bf16 v[52:55], v[128:131], v[180:183], v[52:55]
  buffer_load_dwordx4 v6, s[40:43], s12 offen lds
  v_mfma_f32_16x16x32_bf16 v[68:71], v[132:135], v[180:183], v[68:71]
  buffer_load_dwordx4 v7, s[40:43], s12 offen offset:1024 lds
  buffer_load_dwordx4 v8, s[40:43], s12 offen offset:2048 lds
  v_mfma_f32_16x16x32_bf16 v[84:87], v[136:139], v[180:183], v[84:87]
  s_waitcnt vmcnt(7)
  ds_read_b64_tr_b16 v[148:149], v9 offset:7168
  ds_read_b64_tr_b16 v[150:151], v9 offset:8960
  v_mfma_f32_16x16x32_bf16 v[100:103], v[140:143], v[180:183], v[100:103]
  ds_read_b64_tr_b16 v[152:153], v9 offset:7200
  ds_read_b64_tr_b16 v[154:155], v9 offset:8992
  v_mfma_f32_16x16x32_bf16 v[116:119], v[144:147], v[180:183], v[116:119]
  ds_read_b64_tr_b16 v[156:157], v9 offset:7232
  ds_read_b64_tr_b16 v[158:159], v9 offset:9024
  v_mfma_f32_16x16x32_bf16 v[24:27], v[120:123], v[184:187], v[24:27]
  ds_read_b64_tr_b16 v[160:161], v9 offset:7264
  ds_read_b64_tr_b16 v[162:163], v9 offset:9056
  v_mfma_f32_16x16x32_bf16 v[40:43], v[124:127], v[184:187], v[40:43]
  ds_read_b64_tr_b16 v[164:165], v9 offset:7296
  ds_read_b64_tr_b16 v[166:167], v9 offset:9088
  v_mfma_f32_16x16x32_bf16 v[56:59], v[128:131], v[184:187], v[56:59]
  ds_read_b64_tr_b16 v[168:169], v9 offset:7328
  ds_read_b64_tr_b16 v[170:171], v9 offset:9120
  v_mfma_f32_16x16x32_bf16 v[72:75], v[132:135], v[184:187], v[72:75]
  ds_read_b64_tr_b16 v[172:173], v9 offset:7360
  ds_read_b64_tr_b16 v[174:175], v9 offset:9152
  v_mfma_f32_16x16x32_bf16 v[88:91], v[136:139], v[184:187], v[88:91]
  v_add_u32 v10, s10, v252
  v_add_u32 v11, s10, v253
  s_add_u32 s10, s10, 8
  s_cmp_eq_u32 s10, 104
  s_cselect_b32 s10, 0, s10
  v_mfma_f32_16x16x32_bf16 v[104:107], v[140:143], v[184:187], v[104:107]
  ds_read_b32 v236, v10 offset:32768
  ds_read_b32 v237, v10 offset:34432
  v_mfma_f32_16x16x32_bf16 v[28:31], v[120:123], v[188:191], v[28:31]
  ds_read_b32 v238, v11 offset:32768
  ds_read_b32 v239, v11 offset:34432
  v_mfma_f32_16x16x32_bf16 v[44:47], v[124:127], v[188:191], v[44:47]
  v_mfma_f32_16x16x32_bf16 v[60:63], v[128:131], v[188:191], v[60:63]
  s_add_u32 s12, s12, 26624
  s_cmp_eq_u32 s12, 346112
  s_cselect_b32 s12, 0, s12
  v_mfma_f32_16x16x32_bf16 v[76:79], v[132:135], v[188:191], v[76:79]
  v_mfma_f32_16x16x32_bf16 v[92:95], v[136:139], v[188:191], v[92:95]
  v_mfma_f32_16x16x32_bf16 v[108:111], v[140:143], v[188:191], v[108:111]
  s_waitcnt lgkmcnt(15)
  v_mfma_f32_16x16x32_bf16 v[16:19], v[148:151], v[192:195], v[16:19]
  s_waitcnt lgkmcnt(4)
  s_add_u32 m0, s7, 7168
  v_mfma_f32_16x16x32_bf16 v[32:35], v[152:155], v[192:195], v[32:35]
  s_waitcnt lgkmcnt(3)
  v_xor_b32 v236, v236, v12
  ds_read_b128 v[176:179], v236
  v_mfma_f32_16x16x32_bf16 v[48:51], v[156:159], v[192:195], v[48:51]
  buffer_load_dwordx4 v2, s[40:43], s12 offen lds
  v_mfma_f32_16x16x32_bf16 v[64:67], v[160:163], v[192:195], v[64:67]
  s_waitcnt lgkmcnt(3)
  v_xor_b32 v237, v237, v12
  ds_read_b128 v[180:183], v237
  v_mfma_f32_16x16x32_bf16 v[80:83], v[164:167], v[192:195], v[80:83]
  buffer_load_dwordx4 v3, s[40:43], s12 offen offset:1024 lds
  v_mfma_f32_16x16x32_bf16 v[96:99], v[168:171], v[192:195], v[96:99]
  s_waitcnt lgkmcnt(3)
  v_xor_b32 v238, v238, v12
  ds_read_b128 v[184:187], v238
  v_mfma_f32_16x16x32_bf16 v[112:115], v[172:175], v[192:195], v[112:115]
  buffer_load_dwordx4 v4, s[40:43], s12 offen offset:2048 lds
  v_mfma_f32_16x16x32_bf16 v[20:23], v[148:151], v[196:199], v[20:23]
  s_waitcnt lgkmcnt(3)
  v_xor_b32 v239, v239, v12
  ds_read_b128 v[188:191], v239
  v_mfma_f32_16x16x32_bf16 v[36:39], v[152:155], v[196:199], v[36:39]
  buffer_load_dwordx4 v5, s[40:43], s12 offen offset:3072 lds
  s_add_u32 m0, s7, 11264
  v_mfma_f32_16x16x32_bf16 v[52:55], v[156:159], v[196:199], v[52:55]
  buffer_load_dwordx4 v6, s[40:43], s12 offen lds
  v_mfma_f32_16x16x32_bf16 v[68:71], v[160:163], v[196:199], v[68:71]
  buffer_load_dwordx4 v7, s[40:43], s12 offen offset:1024 lds
  buffer_load_dwordx4 v8, s[40:43], s12 offen offset:2048 lds
  v_mfma_f32_16x16x32_bf16 v[84:87], v[164:167], v[196:199], v[84:87]
  s_waitcnt vmcnt(7)
  ds_read_b64_tr_b16 v[120:121], v9
  ds_read_b64_tr_b16 v[122:123], v9 offset:1792
  v_mfma_f32_16x16x32_bf16 v[100:103], v[168:171], v[196:199], v[100:103]
  ds_read_b64_tr_b16 v[124:125], v9 offset:32
  ds_read_b64_tr_b16 v[126:127], v9 offset:1824
  v_mfma_f32_16x16x32_bf16 v[116:119], v[172:175], v[196:199], v[116:119]
  ds_read_b64_tr_b16 v[128:129], v9 offset:64
  ds_read_b64_tr_b16 v[130:131], v9 offset:1856
  v_mfma_f32_16x16x32_bf16 v[24:27], v[148:151], v[200:203], v[24:27]
  ds_read_b64_tr_b16 v[132:133], v9 offset:96
  ds_read_b64_tr_b16 v[134:135], v9 offset:1888
  v_mfma_f32_16x16x32_bf16 v[40:43], v[152:155], v[200:203], v[40:43]
  ds_read_b64_tr_b16 v[136:137], v9 offset:128
  ds_read_b64_tr_b16 v[138:139], v9 offset:1920
  v_mfma_f32_16x16x32_bf16 v[56:59], v[156:159], v[200:203], v[56:59]
  ds_read_b64_tr_b16 v[140:141], v9 offset:160
  ds_read_b64_tr_b16 v[142:143], v9 offset:1952
  v_mfma_f32_16x16x32_bf16 v[72:75], v[160:163], v[200:203], v[72:75]
  ds_read_b64_tr_b16 v[144:145], v9 offset:192
  ds_read_b64_tr_b16 v[146:147], v9 offset:1984
  v_mfma_f32_16x16x32_bf16 v[88:91], v[164:167], v[200:203], v[88:91]
  v_add_u32 v10, s10, v252
  v_add_u32 v11, s10, v253
  s_add_u32 s10, s10, 8
  s_cmp_eq_u32 s10, 104
  s_cselect_b32 s10, 0, s10
  v_mfma_f32_16x16x32_bf16 v[104:107], v[168:171], v[200:203], v[104:107]
  ds_read_b32 v240, v10 offset:32768
  ds_read_b32 v241, v10 offset:34432
  v_mfma_f32_16x16x32_bf16 v[28:31], v[148:151], v[204:207], v[28:31]
  ds_read_b32 v242, v11 offset:32768
  ds_read_b32 v243, v11 offset:34432
  v_mfma_f32_16x16x32_bf16 v[44:47], v[152:155], v[204:207], v[44:47]
  v_mfma_f32_16x16x32_bf16 v[60:63], v[156:159], v[204:207], v[60:63]
  s_add_u32 s12, s12, 26624
  s_cmp_eq_u32 s12, 346112
  s_cselect_b32 s12, 0, s12
  v_mfma_f32_16x16x32_bf16 v[76:79], v[160:163], v[204:207], v[76:79]
  v_mfma_f32_16x16x32_bf16 v[92:95], v[164:167], v[204:207], v[92:95]
  v_mfma_f32_16x16x32_bf16 v[108:111], v[168:171], v[204:207], v[108:111]
  s_waitcnt lgkmcnt(15)
  v_mfma_f32_16x16x32_bf16 v[16:19], v[120:123], v[176:179], v[16:19]
  s_waitcnt lgkmcnt(4)
  s_add_u32 m0, s7, 0
  v_mfma_f32_16x16x32_bf16 v[32:35], v[124:127], v[176:179], v[32:35]
  s_waitcnt lgkmcnt(3)
  v_xor_b32 v240, v240, v12
  ds_read_b128 v[192:195], v240
  v_mfma_f32_16x16x32_bf16 v[48:51], v[128:131], v[176:179], v[48:51]
  buffer_load_dwordx4 v2, s[40:43], s12 offen lds
  v_mfma_f32_16x16x32_bf16 v[64:67], v[132:135], v[176:179], v[64:67]
  s_waitcnt lgkmcnt(3)
  v_xor_b32 v241, v241, v12
  ds_read_b128 v[196:199], v241
  v_mfma_f32_16x16x32_bf16 v[80:83], v[136:139], v[176:179], v[80:83]
  buffer_load_dwordx4 v3, s[40:43], s12 offen offset:1024 lds
  v_mfma_f32_16x16x32_bf16 v[96:99], v[140:143], v[176:179], v[96:99]
  s_waitcnt lgkmcnt(3)
  v_xor_b32 v242, v242, v12
  ds_read_b128 v[200:203], v242
  v_mfma_f32_16x16x32_bf16 v[112:115], v[144:147], v[176:179], v[112:115]
  buffer_load_dwordx4 v4, s[40:43], s12 offen offset:2048 lds
  v_mfma_f32_16x16x32_bf16 v[20:23], v[120:123], v[180:183], v[20:23]
  s_waitcnt lgkmcnt(3)
  v_xor_b32 v243, v243, v12
  ds_read_b128 v[204:207], v243
  v_mfma_f32_16x16x32_bf16 v[36:39], v[124:127], v[180:183], v[36:39]
  buffer_load_dwordx4 v5, s[40:43], s12 offen offset:3072 lds
  s_add_u32 m0, s7, 4096
  v_mfma_f32_16x16x32_bf16 v[52:55], v[128:131], v[180:183], v[52:55]
  buffer_load_dwordx4 v6, s[40:43], s12 offen lds
  v_mfma_f32_16x16x32_bf16 v[68:71], v[132:135], v[180:183], v[68:71]
  buffer_load_dwordx4 v7, s[40:43], s12 offen offset:1024 lds
  buffer_load_dwordx4 v8, s[40:43], s12 offen offset:2048 lds
  v_mfma_f32_16x16x32_bf16 v[84:87], v[136:139], v[180:183], v[84:87]
  s_waitcnt vmcnt(7)
  ds_read_b64_tr_b16 v[148:149], v9 offset:7168
  ds_read_b64_tr_b16 v[150:151], v9 offset:8960
  v_mfma_f32_16x16x32_bf16 v[100:103], v[140:143], v[180:183], v[100:103]
  ds_read_b64_tr_b16 v[152:153], v9 offset:7200
  ds_read_b64_tr_b16 v[154:155], v9 offset:8992
  v_mfma_f32_16x16x32_bf16 v[116:119], v[144:147], v[180:183], v[116:119]
  ds_read_b64_tr_b16 v[156:157], v9 offset:7232
  ds_read_b64_tr_b16 v[158:159], v9 offset:9024
  v_mfma_f32_16x16x32_bf16 v[24:27], v[120:123], v[184:187], v[24:27]
  ds_read_b64_tr_b16 v[160:161], v9 offset:7264
  ds_read_b64_tr_b16 v[162:163], v9 offset:9056
  v_mfma_f32_16x16x32_bf16 v[40:43], v[124:127], v[184:187], v[40:43]
  ds_read_b64_tr_b16 v[164:165], v9 offset:7296
  ds_read_b64_tr_b16 v[166:167], v9 offset:9088
  v_mfma_f32_16x16x32_bf16 v[56:59], v[128:131], v[184:187], v[56:59]
  ds_read_b64_tr_b16 v[168:169], v9 offset:7328
  ds_read_b64_tr_b16 v[170:171], v9 offset:9120
  v_mfma_f32_16x16x32_bf16 v[72:75], v[132:135], v[184:187], v[72:75]
  ds_read_b64_tr_b16 v[172:173], v9 offset:7360
  ds_read_b64_tr_b16 v[174:175], v9 offset:9152
  v_mfma_f32_16x16x32_bf16 v[88:91], v[136:139], v[184:187], v[88:91]
  v_add_u32 v10, s10, v252
  v_add_u32 v11, s10, v253
  s_add_u32 s10, s10, 8
  s_cmp_eq_u32 s10, 104
  s_cselect_b32 s10, 0, s10
  v_mfma_f32_16x16x32_bf16 v[104:107], v[140:143], v[184:187], v[104:107]
  ds_read_b32 v236, v10 offset:32768
  ds_read_b32 v237, v10 offset:34432
  v_mfma_f32_16x16x32_bf16 v[28:31], v[120:123], v[188:191], v[28:31]
  ds_read_b32 v238, v11 offset:32768
  ds_read_b32 v239, v11 offset:34432
  v_mfma_f32_16x16x32_bf16 v[44:47], v[124:127], v[188:191], v[44:47]
  v_mfma_f32_16x16x32_bf16 v[60:63], v[128:131], v[188:191], v[60:63]
  s_add_u32 s12, s12, 26624
  s_cmp_eq_u32 s12, 346112
  s_cselect_b32 s12, 0, s12
  v_mfma_f32_16x16x32_bf16 v[76:79], v[132:135], v[188:191], v[76:79]
  v_mfma_f32_16x16x32_bf16 v[92:95], v[136:139], v[188:191], v[92:95]
  v_mfma_f32_16x16x32_bf16 v[108:111], v[140:143], v[188:191], v[108:111]
  s_waitcnt lgkmcnt(15)
  v_mfma_f32_16x16x32_bf16 v[16:19], v[148:151], v[192:195], v[16:19]
  s_waitcnt lgkmcnt(4)
  s_add_u32 m0, s7, 7168
  v_mfma_f32_16x16x32_bf16 v[32:35], v[152:155], v[192:195], v[32:35]
  s_waitcnt lgkmcnt(3)
  v_xor_b32 v236, v236, v12
  ds_read_b128 v[176:179], v236
  v_mfma_f32_16x16x32_bf16 v[48:51], v[156:159], v[192:195], v[48:51]
  buffer_load_dwordx4 v2, s[40:43], s12 offen lds
  v_mfma_f32_16x16x32_bf16 v[64:67], v[160:163], v[192:195], v[64:67]
  s_waitcnt lgkmcnt(3)
  v_xor_b32 v237, v237, v12
  ds_read_b128 v[180:183], v237
  v_mfma_f32_16x16x32_bf16 v[80:83], v[164:167], v[192:195], v[80:83]
  buffer_load_dwordx4 v3, s[40:43], s12 offen offset:1024 lds
  v_mfma_f32_16x16x32_bf16 v[96:99], v[168:171], v[192:195], v[96:99]
  s_waitcnt lgkmcnt(3)
  v_xor_b32 v238, v238, v12
  ds_read_b128 v[184:187], v238
  v_mfma_f32_16x16x32_bf16 v[112:115], v[172:175], v[192:195], v[112:115]
  buffer_load_dwordx4 v4, s[40:43], s12 offen offset:2048 lds
  v_mfma_f32_16x16x32_bf16 v[20:23], v[148:151], v[196:199], v[20:23]
  s_waitcnt lgkmcnt(3)
  v_xor_b32 v239, v239, v12
  ds_read_b128 v[188:191], v239
  v_mfma_f32_16x16x32_bf16 v[36:39], v[152:155], v[196:199], v[36:39]
  buffer_load_dwordx4 v5, s[40:43], s12 offen offset:3072 lds
  s_add_u32 m0, s7, 11264
  v_mfma_f32_16x16x32_bf16 v[52:55], v[156:159], v[196:199], v[52:55]
  buffer_load_dwordx4 v6, s[40:43], s12 offen lds
  v_mfma_f32_16x16x32_bf16 v[68:71], v[160:163], v[196:199], v[68:71]
  buffer_load_dwordx4 v7, s[40:43], s12 offen offset:1024 lds
  buffer_load_dwordx4 v8, s[40:43], s12 offen offset:2048 lds
  v_mfma_f32_16x16x32_bf16 v[84:87], v[164:167], v[196:199], v[84:87]
  s_waitcnt vmcnt(7)
  ds_read_b64_tr_b16 v[120:121], v9
  ds_read_b64_tr_b16 v[122:123], v9 offset:1792
  v_mfma_f32_16x16x32_bf16 v[100:103], v[168:171], v[196:199], v[100:103]
  ds_read_b64_tr_b16 v[124:125], v9 offset:32
  ds_read_b64_tr_b16 v[126:127], v9 offset:1824
  v_mfma_f32_16x16x32_bf16 v[116:119], v[172:175], v[196:199], v[116:119]
  ds_read_b64_tr_b16 v[128:129], v9 offset:64
  ds_read_b64_tr_b16 v[130:131], v9 offset:1856
  v_mfma_f32_16x16x32_bf16 v[24:27], v[148:151], v[200:203], v[24:27]
  ds_read_b64_tr_b16 v[132:133], v9 offset:96
  ds_read_b64_tr_b16 v[134:135], v9 offset:1888
  v_mfma_f32_16x16x32_bf16 v[40:43], v[152:155], v[200:203], v[40:43]
  ds_read_b64_tr_b16 v[136:137], v9 offset:128
  ds_read_b64_tr_b16 v[138:139], v9 offset:1920
  v_mfma_f32_16x16x32_bf16 v[56:59], v[156:159], v[200:203], v[56:59]
  ds_read_b64_tr_b16 v[140:141], v9 offset:160
  ds_read_b64_tr_b16 v[142:143], v9 offset:1952
  v_mfma_f32_16x16x32_bf16 v[72:75], v[160:163], v[200:203], v[72:75]
  ds_read_b64_tr_b16 v[144:145], v9 offset:192
  ds_read_b64_tr_b16 v[146:147], v9 offset:1984
  v_mfma_f32_16x16x32_bf16 v[88:91], v[164:167], v[200:203], v[88:91]
  v_add_u32 v10, s10, v252
  v_add_u32 v11, s10, v253
  s_add_u32 s10, s10, 8
  s_cmp_eq_u32 s10, 104
  s_cselect_b32 s10, 0, s10
  v_mfma_f32_16x16x32_bf16 v[104:107], v[168:171], v[200:203], v[104:107]
  ds_read_b32 v240, v10 offset:32768
  ds_read_b32 v241, v10 offset:34432
  v_mfma_f32_16x16x32_bf16 v[28:31], v[148:151], v[204:207], v[28:31]
  ds_read_b32 v242, v11 offset:32768
  ds_read_b32 v243, v11 offset:34432
  v_mfma_f32_16x16x32_bf16 v[44:47], v[152:155], v[204:207], v[44:47]
  v_mfma_f32_16x16x32_bf16 v[60:63], v[156:159], v[204:207], v[60:63]
  s_add_u32 s12, s12, 26624
  s_cmp_eq_u32 s12, 346112
  s_cselect_b32 s12, 0, s12
  v_mfma_f32_16x16x32_bf16 v[76:79], v[160:163], v[204:207], v[76:79]
  v_mfma_f32_16x16x32_bf16 v[92:95], v[164:167], v[204:207], v[92:95]
  v_mfma_f32_16x16x32_bf16 v[108:111], v[168:171], v[204:207], v[108:111]
  s_waitcnt lgkmcnt(15)
  v_mfma_f32_16x16x32_bf16 v[16:19], v[120:123], v[176:179], v[16:19]
  s_waitcnt lgkmcnt(4)
  s_add_u32 m0, s7, 0
  v_mfma_f32_16x16x32_bf16 v[32:35], v[124:127], v[176:179], v[32:35]
  s_waitcnt lgkmcnt(3)
  v_xor_b32 v240, v240, v12
  ds_read_b128 v[192:195], v240
  v_mfma_f32_16x16x32_bf16 v[48:51], v[128:131], v[176:179], v[48:51]
  buffer_load_dwordx4 v2, s[40:43], s12 offen lds
  v_mfma_f32_16x16x32_bf16 v[64:67], v[132:135], v[176:179], v[64:67]
  s_waitcnt lgkmcnt(3)
  v_xor_b32 v241, v241, v12
  ds_read_b128 v[196:199], v241
  v_mfma_f32_16x16x32_bf16 v[80:83], v[136:139], v[176:179], v[80:83]
  buffer_load_dwordx4 v3, s[40:43], s12 offen offset:1024 lds
  v_mfma_f32_16x16x32_bf16 v[96:99], v[140:143], v[176:179], v[96:99]
  s_waitcnt lgkmcnt(3)
  v_xor_b32 v242, v242, v12
  ds_read_b128 v[200:203], v242
  v_mfma_f32_16x16x32_bf16 v[112:115], v[144:147], v[176:179], v[112:115]
  buffer_load_dwordx4 v4, s[40:43], s12 offen offset:2048 lds
  v_mfma_f32_16x16x32_bf16 v[20:23], v[120:123], v[180:183], v[20:23]
  s_waitcnt lgkmcnt(3)
  v_xor_b32 v243, v243, v12
  ds_read_b128 v[204:207], v243
  v_mfma_f32_16x16x32_bf16 v[36:39], v[124:127], v[180:183], v[36:39]
  buffer_load_dwordx4 v5, s[40:43], s12 offen offset:3072 lds
  s_add_u32 m0, s7, 4096
  v_mfma_f32_16x16x32_bf16 v[52:55], v[128:131], v[180:183], v[52:55]
  buffer_load_dwordx4 v6, s[40:43], s12 offen lds
  v_mfma_f32_16x16x32_bf16 v[68:71], v[132:135], v[180:183], v[68:71]
  buffer_load_dwordx4 v7, s[40:43], s12 offen offset:1024 lds
  buffer_load_dwordx4 v8, s[40:43], s12 offen offset:2048 lds
  v_mfma_f32_16x16x32_bf16 v[84:87], v[136:139], v[180:183], v[84:87]
  s_waitcnt vmcnt(7)
  ds_read_b64_tr_b16 v[148:149], v9 offset:7168
  ds_read_b64_tr_b16 v[150:151], v9 offset:8960
  v_mfma_f32_16x16x32_bf16 v[100:103], v[140:143], v[180:183], v[100:103]
  ds_read_b64_tr_b16 v[152:153], v9 offset:7200
  ds_read_b64_tr_b16 v[154:155], v9 offset:8992
  v_mfma_f32_16x16x32_bf16 v[116:119], v[144:147], v[180:183], v[116:119]
  ds_read_b64_tr_b16 v[156:157], v9 offset:7232
  ds_read_b64_tr_b16 v[158:159], v9 offset:9024
  v_mfma_f32_16x16x32_bf16 v[24:27], v[120:123], v[184:187], v[24:27]
  ds_read_b64_tr_b16 v[160:161], v9 offset:7264
  ds_read_b64_tr_b16 v[162:163], v9 offset:9056
  v_mfma_f32_16x16x32_bf16 v[40:43], v[124:127], v[184:187], v[40:43]
  ds_read_b64_tr_b16 v[164:165], v9 offset:7296
  ds_read_b64_tr_b16 v[166:167], v9 offset:9088
  v_mfma_f32_16x16x32_bf16 v[56:59], v[128:131], v[184:187], v[56:59]
  ds_read_b64_tr_b16 v[168:169], v9 offset:7328
  ds_read_b64_tr_b16 v[170:171], v9 offset:9120
  v_mfma_f32_16x16x32_bf16 v[72:75], v[132:135], v[184:187], v[72:75]
  ds_read_b64_tr_b16 v[172:173], v9 offset:7360
  ds_read_b64_tr_b16 v[174:175], v9 offset:9152
  v_mfma_f32_16x16x32_bf16 v[88:91], v[136:139], v[184:187], v[88:91]
  v_add_u32 v10, s10, v252
  v_add_u32 v11, s10, v253
  s_add_u32 s10, s10, 8
  s_cmp_eq_u32 s10, 104
  s_cselect_b32 s10, 0, s10
  v_mfma_f32_16x16x32_bf16 v[104:107], v[140:143], v[184:187], v[104:107]
  ds_read_b32 v236, v10 offset:32768
  ds_read_b32 v237, v10 offset:34432
  v_mfma_f32_16x16x32_bf16 v[28:31], v[120:123], v[188:191], v[28:31]
  ds_read_b32 v238, v11 offset:32768
  ds_read_b32 v239, v11 offset:34432
  v_mfma_f32_16x16x32_bf16 v[44:47], v[124:127], v[188:191], v[44:47]
  v_mfma_f32_16x16x32_bf16 v[60:63], v[128:131], v[188:191], v[60:63]
  s_add_u32 s12, s12, 26624
  s_cmp_eq_u32 s12, 346112
  s_cselect_b32 s12, 0, s12
  v_mfma_f32_16x16x32_bf16 v[76:79], v[132:135], v[188:191], v[76:79]
  v_mfma_f32_16x16x32_bf16 v[92:95], v[136:139], v[188:191], v[92:95]
  v_mfma_f32_16x16x32_bf16 v[108:111], v[140:143], v[188:191], v[108:111]
  s_waitcnt lgkmcnt(15)
  v_mfma_f32_16x16x32_bf16 v[16:19], v[148:151], v[192:195], v[16:19]
  s_waitcnt lgkmcnt(4)
  s_add_u32 m0, s7, 7168
  v_mfma_f32_16x16x32_bf16 v[32:35], v[152:155], v[192:195], v[32:35]
  s_waitcnt lgkmcnt(3)
  v_xor_b32 v236, v236, v12
  ds_read_b128 v[176:179], v236
  v_mfma_f32_16x16x32_bf16 v[48:51], v[156:159], v[192:195], v[48:51]
  buffer_load_dwordx4 v2, s[40:43], s12 offen lds
  v_mfma_f32_16x16x32_bf16 v[64:67], v[160:163], v[192:195], v[64:67]
  s_waitcnt lgkmcnt(3)
  v_xor_b32 v237, v237, v12
  ds_read_b128 v[180:183], v237
  v_mfma_f32_16x16x32_bf16 v[80:83], v[164:167], v[192:195], v[80:83]
  buffer_load_dwordx4 v3, s[40:43], s12 offen offset:1024 lds
  v_mfma_f32_16x16x32_bf16 v[96:99], v[168:171], v[192:195], v[96:99]
  s_waitcnt lgkmcnt(3)
  v_xor_b32 v238, v238, v12
  ds_read_b128 v[184:187], v238
  v_mfma_f32_16x16x32_bf16 v[112:115], v[172:175], v[192:195], v[112:115]
  buffer_load_dwordx4 v4, s[40:43], s12 offen offset:2048 lds
  v_mfma_f32_16x16x32_bf16 v[20:23], v[148:151], v[196:199], v[20:23]
  s_waitcnt lgkmcnt(3)
  v_xor_b32 v239, v239, v12
  ds_read_b128 v[188:191], v239
  v_mfma_f32_16x16x32_bf16 v[36:39], v[152:155], v[196:199], v[36:39]
  buffer_load_dwordx4 v5, s[40:43], s12 offen offset:3072 lds
  s_add_u32 m0, s7, 11264
  v_mfma_f32_16x16x32_bf16 v[52:55], v[156:159], v[196:199], v[52:55]
  buffer_load_dwordx4 v6, s[40:43], s12 offen lds
  v_mfma_f32_16x16x32_bf16 v[68:71], v[160:163], v[196:199], v[68:71]
  buffer_load_dwordx4 v7, s[40:43], s12 offen offset:1024 lds
  buffer_load_dwordx4 v8, s[40:43], s12 offen offset:2048 lds
  v_mfma_f32_16x16x32_bf16 v[84:87], v[164:167], v[196:199], v[84:87]
  s_waitcnt vmcnt(7)
  ds_read_b64_tr_b16 v[120:121], v9
  ds_read_b64_tr_b16 v[122:123], v9 offset:1792
  v_mfma_f32_16x16x32_bf16 v[100:103], v[168:171], v[196:199], v[100:103]
  ds_read_b64_tr_b16 v[124:125], v9 offset:32
  ds_read_b64_tr_b16 v[126:127], v9 offset:1824
  v_mfma_f32_16x16x32_bf16 v[116:119], v[172:175], v[196:199], v[116:119]
  ds_read_b64_tr_b16 v[128:129], v9 offset:64
  ds_read_b64_tr_b16 v[130:131], v9 offset:1856
  v_mfma_f32_16x16x32_bf16 v[24:27], v[148:151], v[200:203], v[24:27]
  ds_read_b64_tr_b16 v[132:133], v9 offset:96
  ds_read_b64_tr_b16 v[134:135], v9 offset:1888
  v_mfma_f32_16x16x32_bf16 v[40:43], v[152:155], v[200:203], v[40:43]
  ds_read_b64_tr_b16 v[136:137], v9 offset:128
  ds_read_b64_tr_b16 v[138:139], v9 offset:1920
  v_mfma_f32_16x16x32_bf16 v[56:59], v[156:159], v[200:203], v[56:59]
  ds_read_b64_tr_b16 v[140:141], v9 offset:160
  ds_read_b64_tr_b16 v[142:143], v9 offset:1952
  v_mfma_f32_16x16x32_bf16 v[72:75], v[160:163], v[200:203], v[72:75]
  ds_read_b64_tr_b16 v[144:145], v9 offset:192
  ds_read_b64_tr_b16 v[146:147], v9 offset:1984
  v_mfma_f32_16x16x32_bf16 v[88:91], v[164:167], v[200:203], v[88:91]
  v_add_u32 v10, s10, v252
  v_add_u32 v11, s10, v253
  s_add_u32 s10, s10, 8
  s_cmp_eq_u32 s10, 104
  s_cselect_b32 s10, 0, s10
  v_mfma_f32_16x16x32_bf16 v[104:107], v[168:171], v[200:203], v[104:107]
  ds_read_b32 v240, v10 offset:32768
  ds_read_b32 v241, v10 offset:34432
  v_mfma_f32_16x16x32_bf16 v[28:31], v[148:151], v[204:207], v[28:31]
  ds_read_b32 v242, v11 offset:32768
  ds_read_b32 v243, v11 offset:34432
  v_mfma_f32_16x16x32_bf16 v[44:47], v[152:155], v[204:207], v[44:47]
  v_mfma_f32_16x16x32_bf16 v[60:63], v[156:159], v[204:207], v[60:63]
  s_add_u32 s12, s12, 26624
  s_cmp_eq_u32 s12, 346112
  s_cselect_b32 s12, 0, s12
  v_mfma_f32_16x16x32_bf16 v[76:79], v[160:163], v[204:207], v[76:79]
  v_mfma_f32_16x16x32_bf16 v[92:95], v[164:167], v[204:207], v[92:95]
  v_mfma_f32_16x16x32_bf16 v[108:111], v[168:171], v[204:207], v[108:111]
  s_waitcnt lgkmcnt(15)
  v_mfma_f32_16x16x32_bf16 v[16:19], v[120:123], v[176:179], v[16:19]
  s_waitcnt lgkmcnt(4)
  s_add_u32 m0, s7, 0
  v_mfma_f32_16x16x32_bf16 v[32:35], v[124:127], v[176:179], v[32:35]
  s_waitcnt lgkmcnt(3)
  v_xor_b32 v240, v240, v12
  ds_read_b128 v[192:195], v240
  v_mfma_f32_16x16x32_bf16 v[48:51], v[128:131], v[176:179], v[48:51]
  buffer_load_dwordx4 v2, s[40:43], s12 offen lds
  v_mfma_f32_16x16x32_bf16 v[64:67], v[132:135], v[176:179], v[64:67]
  s_waitcnt lgkmcnt(3)
  v_xor_b32 v241, v241, v12
  ds_read_b128 v[196:199], v241
  v_mfma_f32_16x16x32_bf16 v[80:83], v[136:139], v[176:179], v[80:83]
  buffer_load_dwordx4 v3, s[40:43], s12 offen offset:1024 lds
  v_mfma_f32_16x16x32_bf16 v[96:99], v[140:143], v[176:179], v[96:99]
  s_waitcnt lgkmcnt(3)
  v_xor_b32 v242, v242, v12
  ds_read_b128 v[200:203], v242
  v_mfma_f32_16x16x32_bf16 v[112:115], v[144:147], v[176:179], v[112:115]
  buffer_load_dwordx4 v4, s[40:43], s12 offen offset:2048 lds
  v_mfma_f32_16x16x32_bf16 v[20:23], v[120:123], v[180:183], v[20:23]
  s_waitcnt lgkmcnt(3)
  v_xor_b32 v243, v243, v12
  ds_read_b128 v[204:207], v243
  v_mfma_f32_16x16x32_bf16 v[36:39], v[124:127], v[180:183], v[36:39]
  buffer_load_dwordx4 v5, s[40:43], s12 offen offset:3072 lds
  s_add_u32 m0, s7, 4096
  v_mfma_f32_16x16x32_bf16 v[52:55], v[128:131], v[180:183], v[52:55]
  buffer_load_dwordx4 v6, s[40:43], s12 offen lds
  v_mfma_f32_16x16x32_bf16 v[68:71], v[132:135], v[180:183], v[68:71]
  buffer_load_dwordx4 v7, s[40:43], s12 offen offset:1024 lds
  buffer_load_dwordx4 v8, s[40:43], s12 offen offset:2048 lds
  v_mfma_f32_16x16x32_bf16 v[84:87], v[136:139], v[180:183], v[84:87]
  s_waitcnt vmcnt(7)
  ds_read_b64_tr_b16 v[148:149], v9 offset:7168
  ds_read_b64_tr_b16 v[150:151], v9 offset:8960
  v_mfma_f32_16x16x32_bf16 v[100:103], v[140:143], v[180:183], v[100:103]
  ds_read_b64_tr_b16 v[152:153], v9 offset:7200
  ds_read_b64_tr_b16 v[154:155], v9 offset:8992
  v_mfma_f32_16x16x32_bf16 v[116:119], v[144:147], v[180:183], v[116:119]
  ds_read_b64_tr_b16 v[156:157], v9 offset:7232
  ds_read_b64_tr_b16 v[158:159], v9 offset:9024
  v_mfma_f32_16x16x32_bf16 v[24:27], v[120:123], v[184:187], v[24:27]
  ds_read_b64_tr_b16 v[160:161], v9 offset:7264
  ds_read_b64_tr_b16 v[162:163], v9 offset:9056
  v_mfma_f32_16x16x32_bf16 v[40:43], v[124:127], v[184:187], v[40:43]
  ds_read_b64_tr_b16 v[164:165], v9 offset:7296
  ds_read_b64_tr_b16 v[166:167], v9 offset:9088
  v_mfma_f32_16x16x32_bf16 v[56:59], v[128:131], v[184:187], v[56:59]
  ds_read_b64_tr_b16 v[168:169], v9 offset:7328
  ds_read_b64_tr_b16 v[170:171], v9 offset:9120
  v_mfma_f32_16x16x32_bf16 v[72:75], v[132:135], v[184:187], v[72:75]
  ds_read_b64_tr_b16 v[172:173], v9 offset:7360
  ds_read_b64_tr_b16 v[174:175], v9 offset:9152
  v_mfma_f32_16x16x32_bf16 v[88:91], v[136:139], v[184:187], v[88:91]
  v_add_u32 v10, s10, v252
  v_add_u32 v11, s10, v253
  s_add_u32 s10, s10, 8
  s_cmp_eq_u32 s10, 104
  s_cselect_b32 s10, 0, s10
  v_mfma_f32_16x16x32_bf16 v[104:107], v[140:143], v[184:187], v[104:107]
  ds_read_b32 v236, v10 offset:32768
  ds_read_b32 v237, v10 offset:34432
  v_mfma_f32_16x16x32_bf16 v[28:31], v[120:123], v[188:191], v[28:31]
  ds_read_b32 v238, v11 offset:32768
  ds_read_b32 v239, v11 offset:34432
  v_mfma_f32_16x16x32_bf16 v[44:47], v[124:127], v[188:191], v[44:47]
  v_mfma_f32_16x16x32_bf16 v[60:63], v[128:131], v[188:191], v[60:63]
  s_add_u32 s12, s12, 26624
  s_cmp_eq_u32 s12, 346112
  s_cselect_b32 s12, 0, s12
  v_mfma_f32_16x16x32_bf16 v[76:79], v[132:135], v[188:191], v[76:79]
  v_mfma_f32_16x16x32_bf16 v[92:95], v[136:139], v[188:191], v[92:95]
  v_mfma_f32_16x16x32_bf16 v[108:111], v[140:143], v[188:191], v[108:111]
  s_waitcnt lgkmcnt(15)
  v_mfma_f32_16x16x32_bf16 v[16:19], v[148:151], v[192:195], v[16:19]
  s_waitcnt lgkmcnt(4)
  s_add_u32 m0, s7, 7168
  v_mfma_f32_16x16x32_bf16 v[32:35], v[152:155], v[192:195], v[32:35]
  s_waitcnt lgkmcnt(3)
  v_xor_b32 v236, v236, v12
  ds_read_b128 v[176:179], v236
  v_mfma_f32_16x16x32_bf16 v[48:51], v[156:159], v[192:195], v[48:51]
  buffer_load_dwordx4 v2, s[40:43], s12 offen lds
  v_mfma_f32_16x16x32_bf16 v[64:67], v[160:163], v[192:195], v[64:67]
  s_waitcnt lgkmcnt(3)
  v_xor_b32 v237, v237, v12
  ds_read_b128 v[180:183], v237
  v_mfma_f32_16x16x32_bf16 v[80:83], v[164:167], v[192:195], v[80:83]
  buffer_load_dwordx4 v3, s[40:43], s12 offen offset:1024 lds
  v_mfma_f32_16x16x32_bf16 v[96:99], v[168:171], v[192:195], v[96:99]
  s_waitcnt lgkmcnt(3)
  v_xor_b32 v238, v238, v12
  ds_read_b128 v[184:187], v238
  v_mfma_f32_16x16x32_bf16 v[112:115], v[172:175], v[192:195], v[112:115]
  buffer_load_dwordx4 v4, s[40:43], s12 offen offset:2048 lds
  v_mfma_f32_16x16x32_bf16 v[20:23], v[148:151], v[196:199], v[20:23]
  s_waitcnt lgkmcnt(3)
  v_xor_b32 v239, v239, v12
  ds_read_b128 v[188:191], v239
  v_mfma_f32_16x16x32_bf16 v[36:39], v[152:155], v[196:199], v[36:39]
  buffer_load_dwordx4 v5, s[40:43], s12 offen offset:3072 lds
  s_add_u32 m0, s7, 11264
  v_mfma_f32_16x16x32_bf16 v[52:55], v[156:159], v[196:199], v[52:55]
  buffer_load_dwordx4 v6, s[40:43], s12 offen lds
  v_mfma_f32_16x16x32_bf16 v[68:71], v[160:163], v[196:199], v[68:71]
  buffer_load_dwordx4 v7, s[40:43], s12 offen offset:1024 lds
  buffer_load_dwordx4 v8, s[40:43], s12 offen offset:2048 lds
  v_mfma_f32_16x16x32_bf16 v[84:87], v[164:167], v[196:199], v[84:87]
  s_waitcnt vmcnt(7)
  ds_read_b64_tr_b16 v[120:121], v9
  ds_read_b64_tr_b16 v[122:123], v9 offset:1792
  v_mfma_f32_16x16x32_bf16 v[100:103], v[168:171], v[196:199], v[100:103]
  ds_read_b64_tr_b16 v[124:125], v9 offset:32
  ds_read_b64_tr_b16 v[126:127], v9 offset:1824
  v_mfma_f32_16x16x32_bf16 v[116:119], v[172:175], v[196:199], v[116:119]
  ds_read_b64_tr_b16 v[128:129], v9 offset:64
  ds_read_b64_tr_b16 v[130:131], v9 offset:1856
  v_mfma_f32_16x16x32_bf16 v[24:27], v[148:151], v[200:203], v[24:27]
  ds_read_b64_tr_b16 v[132:133], v9 offset:96
  ds_read_b64_tr_b16 v[134:135], v9 offset:1888
  v_mfma_f32_16x16x32_bf16 v[40:43], v[152:155], v[200:203], v[40:43]
  ds_read_b64_tr_b16 v[136:137], v9 offset:128
  ds_read_b64_tr_b16 v[138:139], v9 offset:1920
  v_mfma_f32_16x16x32_bf16 v[56:59], v[156:159], v[200:203], v[56:59]
  ds_read_b64_tr_b16 v[140:141], v9 offset:160
  ds_read_b64_tr_b16 v[142:143], v9 offset:1952
  v_mfma_f32_16x16x32_bf16 v[72:75], v[160:163], v[200:203], v[72:75]
  ds_read_b64_tr_b16 v[144:145], v9 offset:192
  ds_read_b64_tr_b16 v[146:147], v9 offset:1984
  v_mfma_f32_16x16x32_bf16 v[88:91], v[164:167], v[200:203], v[88:91]
  v_add_u32 v10, s10, v252
  v_add_u32 v11, s10, v253
  s_add_u32 s10, s10, 8
  s_cmp_eq_u32 s10, 104
  s_cselect_b32 s10, 0, s10
  v_mfma_f32_16x16x32_bf16 v[104:107], v[168:171], v[200:203], v[104:107]
  ds_read_b32 v240, v10 offset:32768
  ds_read_b32 v241, v10 offset:34432
  v_mfma_f32_16x16x32_bf16 v[28:31], v[148:151], v[204:207], v[28:31]
  ds_read_b32 v242, v11 offset:32768
  ds_read_b32 v243, v11 offset:34432
  v_mfma_f32_16x16x32_bf16 v[44:47], v[152:155], v[204:207], v[44:47]
  v_mfma_f32_16x16x32_bf16 v[60:63], v[156:159], v[204:207], v[60:63]
  s_add_u32 s12, s12, 26624
  s_cmp_eq_u32 s12, 346112
  s_cselect_b32 s12, 0, s12
  v_mfma_f32_16x16x32_bf16 v[76:79], v[160:163], v[204:207], v[76:79]
  v_mfma_f32_16x16x32_bf16 v[92:95], v[164:167], v[204:207], v[92:95]
  v_mfma_f32_16x16x32_bf16 v[108:111], v[168:171], v[204:207], v[108:111]
  s_waitcnt lgkmcnt(15)
  v_mfma_f32_16x16x32_bf16 v[16:19], v[120:123], v[176:179], v[16:19]
  s_waitcnt lgkmcnt(4)
  s_add_u32 m0, s7, 0
  v_mfma_f32_16x16x32_bf16 v[32:35], v[124:127], v[176:179], v[32:35]
  s_waitcnt lgkmcnt(3)
  v_xor_b32 v240, v240, v12
  ds_read_b128 v[192:195], v240
  v_mfma_f32_16x16x32_bf16 v[48:51], v[128:131], v[176:179], v[48:51]
  buffer_load_dwordx4 v2, s[40:43], s12 offen lds
  v_mfma_f32_16x16x32_bf16 v[64:67], v[132:135], v[176:179], v[64:67]
  s_waitcnt lgkmcnt(3)
  v_xor_b32 v241, v241, v12
  ds_read_b128 v[196:199], v241
  v_mfma_f32_16x16x32_bf16 v[80:83], v[136:139], v[176:179], v[80:83]
  buffer_load_dwordx4 v3, s[40:43], s12 offen offset:1024 lds
  v_mfma_f32_16x16x32_bf16 v[96:99], v[140:143], v[176:179], v[96:99]
  s_waitcnt lgkmcnt(3)
  v_xor_b32 v242, v242, v12
  ds_read_b128 v[200:203], v242
  v_mfma_f32_16x16x32_bf16 v[112:115], v[144:147], v[176:179], v[112:115]
  buffer_load_dwordx4 v4, s[40:43], s12 offen offset:2048 lds
  v_mfma_f32_16x16x32_bf16 v[20:23], v[120:123], v[180:183], v[20:23]
  s_waitcnt lgkmcnt(3)
  v_xor_b32 v243, v243, v12
  ds_read_b128 v[204:207], v243
  v_mfma_f32_16x16x32_bf16 v[36:39], v[124:127], v[180:183], v[36:39]
  buffer_load_dwordx4 v5, s[40:43], s12 offen offset:3072 lds
  s_add_u32 m0, s7, 4096
  v_mfma_f32_16x16x32_bf16 v[52:55], v[128:131], v[180:183], v[52:55]
  buffer_load_dwordx4 v6, s[40:43], s12 offen lds
  v_mfma_f32_16x16x32_bf16 v[68:71], v[132:135], v[180:183], v[68:71]
  buffer_load_dwordx4 v7, s[40:43], s12 offen offset:1024 lds
  buffer_load_dwordx4 v8, s[40:43], s12 offen offset:2048 lds
  v_mfma_f32_16x16x32_bf16 v[84:87], v[136:139], v[180:183], v[84:87]
  s_waitcnt vmcnt(7)
  ds_read_b64_tr_b16 v[148:149], v9 offset:7168
  ds_read_b64_tr_b16 v[150:151], v9 offset:8960
  v_mfma_f32_16x16x32_bf16 v[100:103], v[140:143], v[180:183], v[100:103]
  ds_read_b64_tr_b16 v[152:153], v9 offset:7200
  ds_read_b64_tr_b16 v[154:155], v9 offset:8992
  v_mfma_f32_16x16x32_bf16 v[116:119], v[144:147], v[180:183], v[116:119]
  ds_read_b64_tr_b16 v[156:157], v9 offset:7232
  ds_read_b64_tr_b16 v[158:159], v9 offset:9024
  v_mfma_f32_16x16x32_bf16 v[24:27], v[120:123], v[184:187], v[24:27]
  ds_read_b64_tr_b16 v[160:161], v9 offset:7264
  ds_read_b64_tr_b16 v[162:163], v9 offset:9056
  v_mfma_f32_16x16x32_bf16 v[40:43], v[124:127], v[184:187], v[40:43]
  ds_read_b64_tr_b16 v[164:165], v9 offset:7296
  ds_read_b64_tr_b16 v[166:167], v9 offset:9088
  v_mfma_f32_16x16x32_bf16 v[56:59], v[128:131], v[184:187], v[56:59]
  ds_read_b64_tr_b16 v[168:169], v9 offset:7328
  ds_read_b64_tr_b16 v[170:171], v9 offset:9120
  v_mfma_f32_16x16x32_bf16 v[72:75], v[132:135], v[184:187], v[72:75]
  ds_read_b64_tr_b16 v[172:173], v9 offset:7360
  ds_read_b64_tr_b16 v[174:175], v9 offset:9152
  v_mfma_f32_16x16x32_bf16 v[88:91], v[136:139], v[184:187], v[88:91]
  v_add_u32 v10, s10, v252
  v_add_u32 v11, s10, v253
  s_add_u32 s10, s10, 8
  s_cmp_eq_u32 s10, 104
  s_cselect_b32 s10, 0, s10
  v_mfma_f32_16x16x32_bf16 v[104:107], v[140:143], v[184:187], v[104:107]
  ds_read_b32 v236, v10 offset:32768
  ds_read_b32 v237, v10 offset:34432
  v_mfma_f32_16x16x32_bf16 v[28:31], v[120:123], v[188:191], v[28:31]
  ds_read_b32 v238, v11 offset:32768
  ds_read_b32 v239, v11 offset:34432
  v_mfma_f32_16x16x32_bf16 v[44:47], v[124:127], v[188:191], v[44:47]
  v_mfma_f32_16x16x32_bf16 v[60:63], v[128:131], v[188:191], v[60:63]
  s_add_u32 s12, s12, 26624
  s_cmp_eq_u32 s12, 346112
  s_cselect_b32 s12, 0, s12
  v_mfma_f32_16x16x32_bf16 v[76:79], v[132:135], v[188:191], v[76:79]
  v_mfma_f32_16x16x32_bf16 v[92:95], v[136:139], v[188:191], v[92:95]
  v_mfma_f32_16x16x32_bf16 v[108:111], v[140:143], v[188:191], v[108:111]
  s_waitcnt lgkmcnt(15)
  v_mfma_f32_16x16x32_bf16 v[16:19], v[148:151], v[192:195], v[16:19]
  s_waitcnt lgkmcnt(14)
  v_mfma_f32_16x16x32_bf16 v[32:35], v[152:155], v[192:195], v[32:35]
  s_waitcnt lgkmcnt(3)
  v_xor_b32 v236, v236, v12
  ds_read_b128 v[176:179], v236
  v_mfma_f32_16x16x32_bf16 v[48:51], v[156:159], v[192:195], v[48:51]
  v_mfma_f32_16x16x32_bf16 v[64:67], v[160:163], v[192:195], v[64:67]
  s_waitcnt lgkmcnt(3)
  v_xor_b32 v237, v237, v12
  ds_read_b128 v[180:183], v237
  v_mfma_f32_16x16x32_bf16 v[80:83], v[164:167], v[192:195], v[80:83]
  v_mfma_f32_16x16x32_bf16 v[96:99], v[168:171], v[192:195], v[96:99]
  s_waitcnt lgkmcnt(3)
  v_xor_b32 v238, v238, v12
  ds_read_b128 v[184:187], v238
  v_mfma_f32_16x16x32_bf16 v[112:115], v[172:175], v[192:195], v[112:115]
  v_mfma_f32_16x16x32_bf16 v[20:23], v[148:151], v[196:199], v[20:23]
  s_waitcnt lgkmcnt(3)
  v_xor_b32 v239, v239, v12
  ds_read_b128 v[188:191], v239
  v_mfma_f32_16x16x32_bf16 v[36:39], v[152:155], v[196:199], v[36:39]
  v_mfma_f32_16x16x32_bf16 v[52:55], v[156:159], v[196:199], v[52:55]
  v_mfma_f32_16x16x32_bf16 v[68:71], v[160:163], v[196:199], v[68:71]
  v_mfma_f32_16x16x32_bf16 v[84:87], v[164:167], v[196:199], v[84:87]
  s_waitcnt vmcnt(0)
  ds_read_b64_tr_b16 v[120:121], v9
  ds_read_b64_tr_b16 v[122:123], v9 offset:1792
  v_mfma_f32_16x16x32_bf16 v[100:103], v[168:171], v[196:199], v[100:103]
  ds_read_b64_tr_b16 v[124:125], v9 offset:32
  ds_read_b64_tr_b16 v[126:127], v9 offset:1824
  v_mfma_f32_16x16x32_bf16 v[116:119], v[172:175], v[196:199], v[116:119]
  ds_read_b64_tr_b16 v[128:129], v9 offset:64
  ds_read_b64_tr_b16 v[130:131], v9 offset:1856
  v_mfma_f32_16x16x32_bf16 v[24:27], v[148:151], v[200:203], v[24:27]
  ds_read_b64_tr_b16 v[132:133], v9 offset:96
  ds_read_b64_tr_b16 v[134:135], v9 offset:1888
  v_mfma_f32_16x16x32_bf16 v[40:43], v[152:155], v[200:203], v[40:43]
  ds_read_b64_tr_b16 v[136:137], v9 offset:128
  ds_read_b64_tr_b16 v[138:139], v9 offset:1920
  v_mfma_f32_16x16x32_bf16 v[56:59], v[156:159], v[200:203], v[56:59]
  ds_read_b64_tr_b16 v[140:141], v9 offset:160
  ds_read_b64_tr_b16 v[142:143], v9 offset:1952
  v_mfma_f32_16x16x32_bf16 v[72:75], v[160:163], v[200:203], v[72:75]
  ds_read_b64_tr_b16 v[144:145], v9 offset:192
  ds_read_b64_tr_b16 v[146:147], v9 offset:1984
  v_mfma_f32_16x16x32_bf16 v[88:91], v[164:167], v[200:203], v[88:91]
  v_mfma_f32_16x16x32_bf16 v[104:107], v[168:171], v[200:203], v[104:107]
  v_mfma_f32_16x16x32_bf16 v[28:31], v[148:151], v[204:207], v[28:31]
  v_mfma_f32_16x16x32_bf16 v[44:47], v[152:155], v[204:207], v[44:47]
  v_mfma_f32_16x16x32_bf16 v[60:63], v[156:159], v[204:207], v[60:63]
  v_mfma_f32_16x16x32_bf16 v[76:79], v[160:163], v[204:207], v[76:79]
  v_mfma_f32_16x16x32_bf16 v[92:95], v[164:167], v[204:207], v[92:95]
  v_mfma_f32_16x16x32_bf16 v[108:111], v[168:171], v[204:207], v[108:111]
  s_waitcnt lgkmcnt(12)
  v_mfma_f32_16x16x32_bf16 v[16:19], v[120:123], v[176:179], v[16:19]
  s_waitcnt lgkmcnt(10)
  v_mfma_f32_16x16x32_bf16 v[32:35], v[124:127], v[176:179], v[32:35]
  s_waitcnt lgkmcnt(8)
  v_mfma_f32_16x16x32_bf16 v[48:51], v[128:131], v[176:179], v[48:51]
  s_waitcnt lgkmcnt(6)
  v_mfma_f32_16x16x32_bf16 v[64:67], v[132:135], v[176:179], v[64:67]
  s_waitcnt lgkmcnt(4)
  v_mfma_f32_16x16x32_bf16 v[80:83], v[136:139], v[176:179], v[80:83]
  s_waitcnt lgkmcnt(2)
  v_mfma_f32_16x16x32_bf16 v[96:99], v[140:143], v[176:179], v[96:99]
  s_waitcnt lgkmcnt(0)
  v_mfma_f32_16x16x32_bf16 v[112:115], v[144:147], v[176:179], v[112:115]
  v_mfma_f32_16x16x32_bf16 v[20:23], v[120:123], v[180:183], v[20:23]
  v_mfma_f32_16x16x32_bf16 v[36:39], v[124:127], v[180:183], v[36:39]
  v_mfma_f32_16x16x32_bf16 v[52:55], v[128:131], v[180:183], v[52:55]
  v_mfma_f32_16x16x32_bf16 v[68:71], v[132:135], v[180:183], v[68:71]
  v_mfma_f32_16x16x32_bf16 v[84:87], v[136:139], v[180:183], v[84:87]
  v_mfma_f32_16x16x32_bf16 v[100:103], v[140:143], v[180:183], v[100:103]
  v_mfma_f32_16x16x32_bf16 v[116:119], v[144:147], v[180:183], v[116:119]
  v_mfma_f32_16x16x32_bf16 v[24:27], v[120:123], v[184:187], v[24:27]
  v_mfma_f32_16x16x32_bf16 v[40:43], v[124:127], v[184:187], v[40:43]
  v_mfma_f32_16x16x32_bf16 v[56:59], v[128:131], v[184:187], v[56:59]
  v_mfma_f32_16x16x32_bf16 v[72:75], v[132:135], v[184:187], v[72:75]
  v_mfma_f32_16x16x32_bf16 v[88:91], v[136:139], v[184:187], v[88:91]
  v_mfma_f32_16x16x32_bf16 v[104:107], v[140:143], v[184:187], v[104:107]
  v_mfma_f32_16x16x32_bf16 v[28:31], v[120:123], v[188:191], v[28:31]
  v_mfma_f32_16x16x32_bf16 v[44:47], v[124:127], v[188:191], v[44:47]
  v_mfma_f32_16x16x32_bf16 v[60:63], v[128:131], v[188:191], v[60:63]
  v_mfma_f32_16x16x32_bf16 v[76:79], v[132:135], v[188:191], v[76:79]
  v_mfma_f32_16x16x32_bf16 v[92:95], v[136:139], v[188:191], v[92:95]
  v_mfma_f32_16x16x32_bf16 v[108:111], v[140:143], v[188:191], v[108:111]
  s_setprio 0
  v_mov_b32 v248, 0x71800000
  v_lshlrev_b32 v246, 16, v15
  v_and_b32 v247, 0xffff0000, v15
  v_rcp_f32 v246, v246
  v_rcp_f32 v247, v247
  v_med3_f32 v246, v246, v248, -v248
  v_med3_f32 v247, v247, v248, -v248
  ds_write_b64 v13, v[246:247] offset:512
  ds_read_b128 v[208:211], v254 offset:512
  ds_read_b128 v[212:215], v254 offset:576
  ds_read_b128 v[216:219], v254 offset:640
  ds_read_b128 v[220:223], v254 offset:704
  ds_read_b128 v[224:227], v254 offset:768
  ds_read_b128 v[228:231], v254 offset:832
  ds_read_b128 v[232:235], v254 offset:896
  v_mov_b32 v120, 0xc0135761
  v_mov_b32 v121, 0xbdd2d3e8
  v_mov_b32 v124, 0
  v_mov_b32 v125, 0
  v_mov_b32 v126, 0
  v_mov_b32 v127, 0
  v_mov_b32 v8, 142336
  v_mov_b32 v9, 1
  v_mul_f32 v128, v16, v16
  v_mul_f32 v129, v20, v20
  v_mul_f32 v130, v24, v24
  v_mul_f32 v131, v28, v28
  v_fma_f32 v128, v128, v121, v120
  v_fma_f32 v129, v129, v121, v120
  v_fma_f32 v130, v130, v121, v120
  v_fma_f32 v131, v131, v121, v120
  v_mul_f32 v128, v16, v128
  v_mul_f32 v129, v20, v129
  v_mul_f32 v130, v24, v130
  v_mul_f32 v131, v28, v131
  v_exp_f32 v128, v128
  v_exp_f32 v129, v129
  v_exp_f32 v130, v130
  v_exp_f32 v131, v131
  s_waitcnt lgkmcnt(6)
  v_fma_f32 v128, v128, v208, v208
  v_fma_f32 v129, v129, v208, v208
  v_fma_f32 v130, v130, v208, v208
  v_fma_f32 v131, v131, v208, v208
  v_rcp_f32 v128, v128
  v_rcp_f32 v129, v129
  v_rcp_f32 v130, v130
  v_rcp_f32 v131, v131
  v_fmac_f32 v124, v16, v128
  v_fmac_f32 v125, v20, v129
  v_fmac_f32 v126, v24, v130
  v_fmac_f32 v127, v28, v131
  v_mul_f32 v132, v17, v17
  v_mul_f32 v133, v21, v21
  v_mul_f32 v134, v25, v25
  v_mul_f32 v135, v29, v29
  v_fma_f32 v132, v132, v121, v120
  v_fma_f32 v133, v133, v121, v120
  v_fma_f32 v134, v134, v121, v120
  v_fma_f32 v135, v135, v121, v120
  v_mul_f32 v132, v17, v132
  v_mul_f32 v133, v21, v133
  v_mul_f32 v134, v25, v134
  v_mul_f32 v135, v29, v135
  v_exp_f32 v132, v132
  v_exp_f32 v133, v133
  v_exp_f32 v134, v134
  v_exp_f32 v135, v135
  v_fma_f32 v132, v132, v209, v209
  v_fma_f32 v133, v133, v209, v209
  v_fma_f32 v134, v134, v209, v209
  v_fma_f32 v135, v135, v209, v209
  v_rcp_f32 v132, v132
  v_rcp_f32 v133, v133
  v_rcp_f32 v134, v134
  v_rcp_f32 v135, v135
  v_fmac_f32 v124, v17, v132
  v_fmac_f32 v125, v21, v133
  v_fmac_f32 v126, v25, v134
  v_fmac_f32 v127, v29, v135
  v_mul_f32 v128, v18, v18
  v_mul_f32 v129, v22, v22
  v_mul_f32 v130, v26, v26
  v_mul_f32 v131, v30, v30
  v_fma_f32 v128, v128, v121, v120
  v_fma_f32 v129, v129, v121, v120
  v_fma_f32 v130, v130, v121, v120
  v_fma_f32 v131, v131, v121, v120
  v_mul_f32 v128, v18, v128
  v_mul_f32 v129, v22, v129
  v_mul_f32 v130, v26, v130
  v_mul_f32 v131, v30, v131
  v_exp_f32 v128, v128
  v_exp_f32 v129, v129
  v_exp_f32 v130, v130
  v_exp_f32 v131, v131
  v_fma_f32 v128, v128, v210, v210
  v_fma_f32 v129, v129, v210, v210
  v_fma_f32 v130, v130, v210, v210
  v_fma_f32 v131, v131, v210, v210
  v_rcp_f32 v128, v128
  v_rcp_f32 v129, v129
  v_rcp_f32 v130, v130
  v_rcp_f32 v131, v131
  v_fmac_f32 v124, v18, v128
  v_fmac_f32 v125, v22, v129
  v_fmac_f32 v126, v26, v130
  v_fmac_f32 v127, v30, v131
  v_mul_f32 v132, v19, v19
  v_mul_f32 v133, v23, v23
  v_mul_f32 v134, v27, v27
  v_mul_f32 v135, v31, v31
  v_fma_f32 v132, v132, v121, v120
  v_fma_f32 v133, v133, v121, v120
  v_fma_f32 v134, v134, v121, v120
  v_fma_f32 v135, v135, v121, v120
  v_mul_f32 v132, v19, v132
  v_mul_f32 v133, v23, v133
  v_mul_f32 v134, v27, v134
  v_mul_f32 v135, v31, v135
  v_exp_f32 v132, v132
  v_exp_f32 v133, v133
  v_exp_f32 v134, v134
  v_exp_f32 v135, v135
  v_fma_f32 v132, v132, v211, v211
  v_fma_f32 v133, v133, v211, v211
  v_fma_f32 v134, v134, v211, v211
  v_fma_f32 v135, v135, v211, v211
  v_rcp_f32 v132, v132
  v_rcp_f32 v133, v133
  v_rcp_f32 v134, v134
  v_rcp_f32 v135, v135
  v_fmac_f32 v124, v19, v132
  v_fmac_f32 v125, v23, v133
  v_fmac_f32 v126, v27, v134
  v_fmac_f32 v127, v31, v135
  v_mul_f32 v128, v32, v32
  v_mul_f32 v129, v36, v36
  v_mul_f32 v130, v40, v40
  v_mul_f32 v131, v44, v44
  v_fma_f32 v128, v128, v121, v120
  v_fma_f32 v129, v129, v121, v120
  v_fma_f32 v130, v130, v121, v120
  v_fma_f32 v131, v131, v121, v120
  v_mul_f32 v128, v32, v128
  v_mul_f32 v129, v36, v129
  v_mul_f32 v130, v40, v130
  v_mul_f32 v131, v44, v131
  v_exp_f32 v128, v128
  v_exp_f32 v129, v129
  v_exp_f32 v130, v130
  v_exp_f32 v131, v131
  s_waitcnt lgkmcnt(5)
  v_fma_f32 v128, v128, v212, v212
  v_fma_f32 v129, v129, v212, v212
  v_fma_f32 v130, v130, v212, v212
  v_fma_f32 v131, v131, v212, v212
  v_rcp_f32 v128, v128
  v_rcp_f32 v129, v129
  v_rcp_f32 v130, v130
  v_rcp_f32 v131, v131
  v_fmac_f32 v124, v32, v128
  v_fmac_f32 v125, v36, v129
  v_fmac_f32 v126, v40, v130
  v_fmac_f32 v127, v44, v131
  v_mul_f32 v132, v33, v33
  v_mul_f32 v133, v37, v37
  v_mul_f32 v134, v41, v41
  v_mul_f32 v135, v45, v45
  v_fma_f32 v132, v132, v121, v120
  v_fma_f32 v133, v133, v121, v120
  v_fma_f32 v134, v134, v121, v120
  v_fma_f32 v135, v135, v121, v120
  v_mul_f32 v132, v33, v132
  v_mul_f32 v133, v37, v133
  v_mul_f32 v134, v41, v134
  v_mul_f32 v135, v45, v135
  v_exp_f32 v132, v132
  v_exp_f32 v133, v133
  v_exp_f32 v134, v134
  v_exp_f32 v135, v135
  v_fma_f32 v132, v132, v213, v213
  v_fma_f32 v133, v133, v213, v213
  v_fma_f32 v134, v134, v213, v213
  v_fma_f32 v135, v135, v213, v213
  v_rcp_f32 v132, v132
  v_rcp_f32 v133, v133
  v_rcp_f32 v134, v134
  v_rcp_f32 v135, v135
  v_fmac_f32 v124, v33, v132
  v_fmac_f32 v125, v37, v133
  v_fmac_f32 v126, v41, v134
  v_fmac_f32 v127, v45, v135
  v_mul_f32 v128, v34, v34
  v_mul_f32 v129, v38, v38
  v_mul_f32 v130, v42, v42
  v_mul_f32 v131, v46, v46
  v_fma_f32 v128, v128, v121, v120
  v_fma_f32 v129, v129, v121, v120
  v_fma_f32 v130, v130, v121, v120
  v_fma_f32 v131, v131, v121, v120
  v_mul_f32 v128, v34, v128
  v_mul_f32 v129, v38, v129
  v_mul_f32 v130, v42, v130
  v_mul_f32 v131, v46, v131
  v_exp_f32 v128, v128
  v_exp_f32 v129, v129
  v_exp_f32 v130, v130
  v_exp_f32 v131, v131
  v_fma_f32 v128, v128, v214, v214
  v_fma_f32 v129, v129, v214, v214
  v_fma_f32 v130, v130, v214, v214
  v_fma_f32 v131, v131, v214, v214
  v_rcp_f32 v128, v128
  v_rcp_f32 v129, v129
  v_rcp_f32 v130, v130
  v_rcp_f32 v131, v131
  v_fmac_f32 v124, v34, v128
  v_fmac_f32 v125, v38, v129
  v_fmac_f32 v126, v42, v130
  v_fmac_f32 v127, v46, v131
  v_mul_f32 v132, v35, v35
  v_mul_f32 v133, v39, v39
  v_mul_f32 v134, v43, v43
  v_mul_f32 v135, v47, v47
  v_fma_f32 v132, v132, v121, v120
  v_fma_f32 v133, v133, v121, v120
  v_fma_f32 v134, v134, v121, v120
  v_fma_f32 v135, v135, v121, v120
  v_mul_f32 v132, v35, v132
  v_mul_f32 v133, v39, v133
  v_mul_f32 v134, v43, v134
  v_mul_f32 v135, v47, v135
  v_exp_f32 v132, v132
  v_exp_f32 v133, v133
  v_exp_f32 v134, v134
  v_exp_f32 v135, v135
  v_fma_f32 v132, v132, v215, v215
  v_fma_f32 v133, v133, v215, v215
  v_fma_f32 v134, v134, v215, v215
  v_fma_f32 v135, v135, v215, v215
  v_rcp_f32 v132, v132
  v_rcp_f32 v133, v133
  v_rcp_f32 v134, v134
  v_rcp_f32 v135, v135
  v_fmac_f32 v124, v35, v132
  v_fmac_f32 v125, v39, v133
  v_fmac_f32 v126, v43, v134
  v_fmac_f32 v127, v47, v135
  v_mul_f32 v128, v48, v48
  v_mul_f32 v129, v52, v52
  v_mul_f32 v130, v56, v56
  v_mul_f32 v131, v60, v60
  v_fma_f32 v128, v128, v121, v120
  v_fma_f32 v129, v129, v121, v120
  v_fma_f32 v130, v130, v121, v120
  v_fma_f32 v131, v131, v121, v120
  v_mul_f32 v128, v48, v128
  v_mul_f32 v129, v52, v129
  v_mul_f32 v130, v56, v130
  v_mul_f32 v131, v60, v131
  v_exp_f32 v128, v128
  v_exp_f32 v129, v129
  v_exp_f32 v130, v130
  v_exp_f32 v131, v131
  s_waitcnt lgkmcnt(4)
  v_fma_f32 v128, v128, v216, v216
  v_fma_f32 v129, v129, v216, v216
  v_fma_f32 v130, v130, v216, v216
  v_fma_f32 v131, v131, v216, v216
  v_rcp_f32 v128, v128
  v_rcp_f32 v129, v129
  v_rcp_f32 v130, v130
  v_rcp_f32 v131, v131
  v_fmac_f32 v124, v48, v128
  v_fmac_f32 v125, v52, v129
  v_fmac_f32 v126, v56, v130
  v_fmac_f32 v127, v60, v131
  v_mul_f32 v132, v49, v49
  v_mul_f32 v133, v53, v53
  v_mul_f32 v134, v57, v57
  v_mul_f32 v135, v61, v61
  v_fma_f32 v132, v132, v121, v120
  v_fma_f32 v133, v133, v121, v120
  v_fma_f32 v134, v134, v121, v120
  v_fma_f32 v135, v135, v121, v120
  v_mul_f32 v132, v49, v132
  v_mul_f32 v133, v53, v133
  v_mul_f32 v134, v57, v134
  v_mul_f32 v135, v61, v135
  v_exp_f32 v132, v132
  v_exp_f32 v133, v133
  v_exp_f32 v134, v134
  v_exp_f32 v135, v135
  v_fma_f32 v132, v132, v217, v217
  v_fma_f32 v133, v133, v217, v217
  v_fma_f32 v134, v134, v217, v217
  v_fma_f32 v135, v135, v217, v217
  v_rcp_f32 v132, v132
  v_rcp_f32 v133, v133
  v_rcp_f32 v134, v134
  v_rcp_f32 v135, v135
  v_fmac_f32 v124, v49, v132
  v_fmac_f32 v125, v53, v133
  v_fmac_f32 v126, v57, v134
  v_fmac_f32 v127, v61, v135
  v_mul_f32 v128, v50, v50
  v_mul_f32 v129, v54, v54
  v_mul_f32 v130, v58, v58
  v_mul_f32 v131, v62, v62
  v_fma_f32 v128, v128, v121, v120
  v_fma_f32 v129, v129, v121, v120
  v_fma_f32 v130, v130, v121, v120
  v_fma_f32 v131, v131, v121, v120
  v_mul_f32 v128, v50, v128
  v_mul_f32 v129, v54, v129
  v_mul_f32 v130, v58, v130
  v_mul_f32 v131, v62, v131
  v_exp_f32 v128, v128
  v_exp_f32 v129, v129
  v_exp_f32 v130, v130
  v_exp_f32 v131, v131
  v_fma_f32 v128, v128, v218, v218
  v_fma_f32 v129, v129, v218, v218
  v_fma_f32 v130, v130, v218, v218
  v_fma_f32 v131, v131, v218, v218
  v_rcp_f32 v128, v128
  v_rcp_f32 v129, v129
  v_rcp_f32 v130, v130
  v_rcp_f32 v131, v131
  v_fmac_f32 v124, v50, v128
  v_fmac_f32 v125, v54, v129
  v_fmac_f32 v126, v58, v130
  v_fmac_f32 v127, v62, v131
  v_mul_f32 v132, v51, v51
  v_mul_f32 v133, v55, v55
  v_mul_f32 v134, v59, v59
  v_mul_f32 v135, v63, v63
  v_fma_f32 v132, v132, v121, v120
  v_fma_f32 v133, v133, v121, v120
  v_fma_f32 v134, v134, v121, v120
  v_fma_f32 v135, v135, v121, v120
  v_mul_f32 v132, v51, v132
  v_mul_f32 v133, v55, v133
  v_mul_f32 v134, v59, v134
  v_mul_f32 v135, v63, v135
  v_exp_f32 v132, v132
  v_exp_f32 v133, v133
  v_exp_f32 v134, v134
  v_exp_f32 v135, v135
  v_fma_f32 v132, v132, v219, v219
  v_fma_f32 v133, v133, v219, v219
  v_fma_f32 v134, v134, v219, v219
  v_fma_f32 v135, v135, v219, v219
  v_rcp_f32 v132, v132
  v_rcp_f32 v133, v133
  v_rcp_f32 v134, v134
  v_rcp_f32 v135, v135
  v_fmac_f32 v124, v51, v132
  v_fmac_f32 v125, v55, v133
  v_fmac_f32 v126, v59, v134
  v_fmac_f32 v127, v63, v135
  v_mul_f32 v128, v64, v64
  v_mul_f32 v129, v68, v68
  v_mul_f32 v130, v72, v72
  v_mul_f32 v131, v76, v76
  v_fma_f32 v128, v128, v121, v120
  v_fma_f32 v129, v129, v121, v120
  v_fma_f32 v130, v130, v121, v120
  v_fma_f32 v131, v131, v121, v120
  v_mul_f32 v128, v64, v128
  v_mul_f32 v129, v68, v129
  v_mul_f32 v130, v72, v130
  v_mul_f32 v131, v76, v131
  v_exp_f32 v128, v128
  v_exp_f32 v129, v129
  v_exp_f32 v130, v130
  v_exp_f32 v131, v131
  s_waitcnt lgkmcnt(3)
  v_fma_f32 v128, v128, v220, v220
  v_fma_f32 v129, v129, v220, v220
  v_fma_f32 v130, v130, v220, v220
  v_fma_f32 v131, v131, v220, v220
  v_rcp_f32 v128, v128
  v_rcp_f32 v129, v129
  v_rcp_f32 v130, v130
  v_rcp_f32 v131, v131
  v_fmac_f32 v124, v64, v128
  v_fmac_f32 v125, v68, v129
  v_fmac_f32 v126, v72, v130
  v_fmac_f32 v127, v76, v131
  v_mul_f32 v132, v65, v65
  v_mul_f32 v133, v69, v69
  v_mul_f32 v134, v73, v73
  v_mul_f32 v135, v77, v77
  v_fma_f32 v132, v132, v121, v120
  v_fma_f32 v133, v133, v121, v120
  v_fma_f32 v134, v134, v121, v120
  v_fma_f32 v135, v135, v121, v120
  v_mul_f32 v132, v65, v132
  v_mul_f32 v133, v69, v133
  v_mul_f32 v134, v73, v134
  v_mul_f32 v135, v77, v135
  v_exp_f32 v132, v132
  v_exp_f32 v133, v133
  v_exp_f32 v134, v134
  v_exp_f32 v135, v135
  v_fma_f32 v132, v132, v221, v221
  v_fma_f32 v133, v133, v221, v221
  v_fma_f32 v134, v134, v221, v221
  v_fma_f32 v135, v135, v221, v221
  v_rcp_f32 v132, v132
  v_rcp_f32 v133, v133
  v_rcp_f32 v134, v134
  v_rcp_f32 v135, v135
  v_fmac_f32 v124, v65, v132
  v_fmac_f32 v125, v69, v133
  v_fmac_f32 v126, v73, v134
  v_fmac_f32 v127, v77, v135
  v_mul_f32 v128, v66, v66
  v_mul_f32 v129, v70, v70
  v_mul_f32 v130, v74, v74
  v_mul_f32 v131, v78, v78
  v_fma_f32 v128, v128, v121, v120
  v_fma_f32 v129, v129, v121, v120
  v_fma_f32 v130, v130, v121, v120
  v_fma_f32 v131, v131, v121, v120
  v_mul_f32 v128, v66, v128
  v_mul_f32 v129, v70, v129
  v_mul_f32 v130, v74, v130
  v_mul_f32 v131, v78, v131
  v_exp_f32 v128, v128
  v_exp_f32 v129, v129
  v_exp_f32 v130, v130
  v_exp_f32 v131, v131
  v_fma_f32 v128, v128, v222, v222
  v_fma_f32 v129, v129, v222, v222
  v_fma_f32 v130, v130, v222, v222
  v_fma_f32 v131, v131, v222, v222
  v_rcp_f32 v128, v128
  v_rcp_f32 v129, v129
  v_rcp_f32 v130, v130
  v_rcp_f32 v131, v131
  v_fmac_f32 v124, v66, v128
  v_fmac_f32 v125, v70, v129
  v_fmac_f32 v126, v74, v130
  v_fmac_f32 v127, v78, v131
  v_mul_f32 v132, v67, v67
  v_mul_f32 v133, v71, v71
  v_mul_f32 v134, v75, v75
  v_mul_f32 v135, v79, v79
  v_fma_f32 v132, v132, v121, v120
  v_fma_f32 v133, v133, v121, v120
  v_fma_f32 v134, v134, v121, v120
  v_fma_f32 v135, v135, v121, v120
  v_mul_f32 v132, v67, v132
  v_mul_f32 v133, v71, v133
  v_mul_f32 v134, v75, v134
  v_mul_f32 v135, v79, v135
  v_exp_f32 v132, v132
  v_exp_f32 v133, v133
  v_exp_f32 v134, v134
  v_exp_f32 v135, v135
  v_fma_f32 v132, v132, v223, v223
  v_fma_f32 v133, v133, v223, v223
  v_fma_f32 v134, v134, v223, v223
  v_fma_f32 v135, v135, v223, v223
  v_rcp_f32 v132, v132
  v_rcp_f32 v133, v133
  v_rcp_f32 v134, v134
  v_rcp_f32 v135, v135
  v_fmac_f32 v124, v67, v132
  v_fmac_f32 v125, v71, v133
  v_fmac_f32 v126, v75, v134
  v_fmac_f32 v127, v79, v135
  v_mul_f32 v128, v80, v80
  v_mul_f32 v129, v84, v84
  v_mul_f32 v130, v88, v88
  v_mul_f32 v131, v92, v92
  v_fma_f32 v128, v128, v121, v120
  v_fma_f32 v129, v129, v121, v120
  v_fma_f32 v130, v130, v121, v120
  v_fma_f32 v131, v131, v121, v120
  v_mul_f32 v128, v80, v128
  v_mul_f32 v129, v84, v129
  v_mul_f32 v130, v88, v130
  v_mul_f32 v131, v92, v131
  v_exp_f32 v128, v128
  v_exp_f32 v129, v129
  v_exp_f32 v130, v130
  v_exp_f32 v131, v131
  s_waitcnt lgkmcnt(2)
  v_fma_f32 v128, v128, v224, v224
  v_fma_f32 v129, v129, v224, v224
  v_fma_f32 v130, v130, v224, v224
  v_fma_f32 v131, v131, v224, v224
  v_rcp_f32 v128, v128
  v_rcp_f32 v129, v129
  v_rcp_f32 v130, v130
  v_rcp_f32 v131, v131
  v_fmac_f32 v124, v80, v128
  v_fmac_f32 v125, v84, v129
  v_fmac_f32 v126, v88, v130
  v_fmac_f32 v127, v92, v131
  v_mul_f32 v132, v81, v81
  v_mul_f32 v133, v85, v85
  v_mul_f32 v134, v89, v89
  v_mul_f32 v135, v93, v93
  v_fma_f32 v132, v132, v121, v120
  v_fma_f32 v133, v133, v121, v120
  v_fma_f32 v134, v134, v121, v120
  v_fma_f32 v135, v135, v121, v120
  v_mul_f32 v132, v81, v132
  v_mul_f32 v133, v85, v133
  v_mul_f32 v134, v89, v134
  v_mul_f32 v135, v93, v135
  v_exp_f32 v132, v132
  v_exp_f32 v133, v133
  v_exp_f32 v134, v134
  v_exp_f32 v135, v135
  v_fma_f32 v132, v132, v225, v225
  v_fma_f32 v133, v133, v225, v225
  v_fma_f32 v134, v134, v225, v225
  v_fma_f32 v135, v135, v225, v225
  v_rcp_f32 v132, v132
  v_rcp_f32 v133, v133
  v_rcp_f32 v134, v134
  v_rcp_f32 v135, v135
  v_fmac_f32 v124, v81, v132
  v_fmac_f32 v125, v85, v133
  v_fmac_f32 v126, v89, v134
  v_fmac_f32 v127, v93, v135
  v_mul_f32 v128, v82, v82
  v_mul_f32 v129, v86, v86
  v_mul_f32 v130, v90, v90
  v_mul_f32 v131, v94, v94
  v_fma_f32 v128, v128, v121, v120
  v_fma_f32 v129, v129, v121, v120
  v_fma_f32 v130, v130, v121, v120
  v_fma_f32 v131, v131, v121, v120
  v_mul_f32 v128, v82, v128
  v_mul_f32 v129, v86, v129
  v_mul_f32 v130, v90, v130
  v_mul_f32 v131, v94, v131
  v_exp_f32 v128, v128
  v_exp_f32 v129, v129
  v_exp_f32 v130, v130
  v_exp_f32 v131, v131
  v_fma_f32 v128, v128, v226, v226
  v_fma_f32 v129, v129, v226, v226
  v_fma_f32 v130, v130, v226, v226
  v_fma_f32 v131, v131, v226, v226
  v_rcp_f32 v128, v128
  v_rcp_f32 v129, v129
  v_rcp_f32 v130, v130
  v_rcp_f32 v131, v131
  v_fmac_f32 v124, v82, v128
  v_fmac_f32 v125, v86, v129
  v_fmac_f32 v126, v90, v130
  v_fmac_f32 v127, v94, v131
  v_mul_f32 v132, v83, v83
  v_mul_f32 v133, v87, v87
  v_mul_f32 v134, v91, v91
  v_mul_f32 v135, v95, v95
  v_fma_f32 v132, v132, v121, v120
  v_fma_f32 v133, v133, v121, v120
  v_fma_f32 v134, v134, v121, v120
  v_fma_f32 v135, v135, v121, v120
  v_mul_f32 v132, v83, v132
  v_mul_f32 v133, v87, v133
  v_mul_f32 v134, v91, v134
  v_mul_f32 v135, v95, v135
  v_exp_f32 v132, v132
  v_exp_f32 v133, v133
  v_exp_f32 v134, v134
  v_exp_f32 v135, v135
  v_fma_f32 v132, v132, v227, v227
  v_fma_f32 v133, v133, v227, v227
  v_fma_f32 v134, v134, v227, v227
  v_fma_f32 v135, v135, v227, v227
  v_rcp_f32 v132, v132
  v_rcp_f32 v133, v133
  v_rcp_f32 v134, v134
  v_rcp_f32 v135, v135
  v_fmac_f32 v124, v83, v132
  v_fmac_f32 v125, v87, v133
  v_fmac_f32 v126, v91, v134
  v_fmac_f32 v127, v95, v135
  v_mul_f32 v128, v96, v96
  v_mul_f32 v129, v100, v100
  v_mul_f32 v130, v104, v104
  v_mul_f32 v131, v108, v108
  v_fma_f32 v128, v128, v121, v120
  v_fma_f32 v129, v129, v121, v120
  v_fma_f32 v130, v130, v121, v120
  v_fma_f32 v131, v131, v121, v120
  v_mul_f32 v128, v96, v128
  v_mul_f32 v129, v100, v129
  v_mul_f32 v130, v104, v130
  v_mul_f32 v131, v108, v131
  v_exp_f32 v128, v128
  v_exp_f32 v129, v129
  v_exp_f32 v130, v130
  v_exp_f32 v131, v131
  s_waitcnt lgkmcnt(1)
  v_fma_f32 v128, v128, v228, v228
  v_fma_f32 v129, v129, v228, v228
  v_fma_f32 v130, v130, v228, v228
  v_fma_f32 v131, v131, v228, v228
  v_rcp_f32 v128, v128
  v_rcp_f32 v129, v129
  v_rcp_f32 v130, v130
  v_rcp_f32 v131, v131
  v_fmac_f32 v124, v96, v128
  v_fmac_f32 v125, v100, v129
  v_fmac_f32 v126, v104, v130
  v_fmac_f32 v127, v108, v131
  v_mul_f32 v132, v97, v97
  v_mul_f32 v133, v101, v101
  v_mul_f32 v134, v105, v105
  v_mul_f32 v135, v109, v109
  v_fma_f32 v132, v132, v121, v120
  v_fma_f32 v133, v133, v121, v120
  v_fma_f32 v134, v134, v121, v120
  v_fma_f32 v135, v135, v121, v120
  v_mul_f32 v132, v97, v132
  v_mul_f32 v133, v101, v133
  v_mul_f32 v134, v105, v134
  v_mul_f32 v135, v109, v135
  v_exp_f32 v132, v132
  v_exp_f32 v133, v133
  v_exp_f32 v134, v134
  v_exp_f32 v135, v135
  v_fma_f32 v132, v132, v229, v229
  v_fma_f32 v133, v133, v229, v229
  v_fma_f32 v134, v134, v229, v229
  v_fma_f32 v135, v135, v229, v229
  v_rcp_f32 v132, v132
  v_rcp_f32 v133, v133
  v_rcp_f32 v134, v134
  v_rcp_f32 v135, v135
  v_fmac_f32 v124, v97, v132
  v_fmac_f32 v125, v101, v133
  v_fmac_f32 v126, v105, v134
  v_fmac_f32 v127, v109, v135
  v_mul_f32 v128, v98, v98
  v_mul_f32 v129, v102, v102
  v_mul_f32 v130, v106, v106
  v_mul_f32 v131, v110, v110
  v_fma_f32 v128, v128, v121, v120
  v_fma_f32 v129, v129, v121, v120
  v_fma_f32 v130, v130, v121, v120
  v_fma_f32 v131, v131, v121, v120
  v_mul_f32 v128, v98, v128
  v_mul_f32 v129, v102, v129
  v_mul_f32 v130, v106, v130
  v_mul_f32 v131, v110, v131
  v_exp_f32 v128, v128
  v_exp_f32 v129, v129
  v_exp_f32 v130, v130
  v_exp_f32 v131, v131
  v_fma_f32 v128, v128, v230, v230
  v_fma_f32 v129, v129, v230, v230
  v_fma_f32 v130, v130, v230, v230
  v_fma_f32 v131, v131, v230, v230
  v_rcp_f32 v128, v128
  v_rcp_f32 v129, v129
  v_rcp_f32 v130, v130
  v_rcp_f32 v131, v131
  v_fmac_f32 v124, v98, v128
  v_fmac_f32 v125, v102, v129
  v_fmac_f32 v126, v106, v130
  v_fmac_f32 v127, v110, v131
  v_mul_f32 v132, v99, v99
  v_mul_f32 v133, v103, v103
  v_mul_f32 v134, v107, v107
  v_mul_f32 v135, v111, v111
  v_fma_f32 v132, v132, v121, v120
  v_fma_f32 v133, v133, v121, v120
  v_fma_f32 v134, v134, v121, v120
  v_fma_f32 v135, v135, v121, v120
  v_mul_f32 v132, v99, v132
  v_mul_f32 v133, v103, v133
  v_mul_f32 v134, v107, v134
  v_mul_f32 v135, v111, v135
  v_exp_f32 v132, v132
  v_exp_f32 v133, v133
  v_exp_f32 v134, v134
  v_exp_f32 v135, v135
  v_fma_f32 v132, v132, v231, v231
  v_fma_f32 v133, v133, v231, v231
  v_fma_f32 v134, v134, v231, v231
  v_fma_f32 v135, v135, v231, v231
  v_rcp_f32 v132, v132
  v_rcp_f32 v133, v133
  v_rcp_f32 v134, v134
  v_rcp_f32 v135, v135
  v_fmac_f32 v124, v99, v132
  v_fmac_f32 v125, v103, v133
  v_fmac_f32 v126, v107, v134
  v_fmac_f32 v127, v111, v135
  v_mul_f32 v128, v112, v112
  v_mul_f32 v129, v116, v116
  v_mul_f32 v130, v113, v113
  v_mul_f32 v131, v117, v117
  v_fma_f32 v128, v128, v121, v120
  v_fma_f32 v129, v129, v121, v120
  v_fma_f32 v130, v130, v121, v120
  v_fma_f32 v131, v131, v121, v120
  v_mul_f32 v128, v112, v128
  v_mul_f32 v129, v116, v129
  v_mul_f32 v130, v113, v130
  v_mul_f32 v131, v117, v131
  v_exp_f32 v128, v128
  v_exp_f32 v129, v129
  v_exp_f32 v130, v130
  v_exp_f32 v131, v131
  s_waitcnt lgkmcnt(0)
  v_fma_f32 v128, v128, v232, v232
  v_fma_f32 v129, v129, v232, v232
  v_fma_f32 v130, v130, v233, v233
  v_fma_f32 v131, v131, v233, v233
  v_rcp_f32 v128, v128
  v_rcp_f32 v129, v129
  v_rcp_f32 v130, v130
  v_rcp_f32 v131, v131
  v_fmac_f32 v124, v112, v128
  v_fmac_f32 v125, v116, v129
  v_fmac_f32 v124, v113, v130
  v_fmac_f32 v125, v117, v131
  v_mul_f32 v132, v114, v114
  v_mul_f32 v133, v118, v118
  v_mul_f32 v134, v115, v115
  v_mul_f32 v135, v119, v119
  v_fma_f32 v132, v132, v121, v120
  v_fma_f32 v133, v133, v121, v120
  v_fma_f32 v134, v134, v121, v120
  v_fma_f32 v135, v135, v121, v120
  v_mul_f32 v132, v114, v132
  v_mul_f32 v133, v118, v133
  v_mul_f32 v134, v115, v134
  v_mul_f32 v135, v119, v135
  v_exp_f32 v132, v132
  v_exp_f32 v133, v133
  v_exp_f32 v134, v134
  v_exp_f32 v135, v135
  v_fma_f32 v132, v132, v234, v234
  v_fma_f32 v133, v133, v234, v234
  v_fma_f32 v134, v134, v235, v235
  v_fma_f32 v135, v135, v235, v235
  v_rcp_f32 v132, v132
  v_rcp_f32 v133, v133
  v_rcp_f32 v134, v134
  v_rcp_f32 v135, v135
  v_fmac_f32 v124, v114, v132
  v_fmac_f32 v125, v118, v133
  v_fmac_f32 v124, v115, v134
  v_fmac_f32 v125, v119, v135
  s_lshl_b32 s5, s14, 9
  s_add_u32 s9, s7, s5
  s_sub_u32 s5, s7, s5
  s_add_u32 s5, s5, 512
  v_lshl_add_u32 v10, v1, 2, s9
  v_lshl_add_u32 v11, v1, 2, s5
  ds_write_b32 v10, v124
  ds_write_b32 v10, v125 offset:256
  ds_write_b32 v11, v126
  ds_write_b32 v11, v127 offset:256
  s_mov_b64 exec, 1
  ds_add_u32 v8, v9 offset:4
  s_mov_b64 exec, -1
L_end:
  s_endpgm
.p2align 6
.type L_lut,@object
L_lut:
  .long 0x03200138, 0x03200320, 0x03200320, 0x03200320
  .long 0x02d0013a, 0x03240324, 0x03240324, 0x03240324
  .long 0x02a20000, 0x03280154, 0x03280328, 0x03280328
  .long 0x02a00002, 0x02b802ba, 0x032c032c, 0x032c032c
  .long 0x02a60004, 0x01820018, 0x03300330, 0x03300330
  .long 0x02a40006, 0x0180001a, 0x03340334, 0x03340334
  .long 0x02aa0008, 0x0186001c, 0x03380338, 0x03380338
  .long 0x02a8000a, 0x0184001e, 0x033c033c, 0x033c033c
  .long 0x02ae000c, 0x018a0020, 0x03400140, 0x03400340
  .long 0x02ac000e, 0x01880022, 0x02d60142, 0x03440344
  .long 0x02b20010, 0x018e0024, 0x01ca0060, 0x03480158
  .long 0x02b00012, 0x018c0026, 0x01c80062, 0x02c002c2
  .long 0x02b60014, 0x01920028, 0x01ce0064, 0x01e20078
  .long 0x02b40016, 0x0190002a, 0x01cc0066, 0x01e0007a
  .long 0x00be00bc, 0x0196002c, 0x01d20068, 0x01e6007c
  .long 0x02240226, 0x0194002e, 0x01d0006a, 0x01e4007e
  .long 0x00d200d0, 0x00d600d4, 0x01d6006c, 0x01ea0080
  .long 0x0238023a, 0x023c023e, 0x01d4006e, 0x01e80082
  .long 0x00e600e4, 0x00ea00e8, 0x01da0070, 0x01ee0084
  .long 0x024c024e, 0x02500252, 0x01d80072, 0x01ec0086
  .long 0x00fa00f8, 0x00fe00fc, 0x01de0074, 0x01f20088
  .long 0x02600262, 0x02640266, 0x01dc0076, 0x01f0008a
  .long 0x010e010c, 0x01120110, 0x011e011c, 0x01f6008c
  .long 0x02740276, 0x0278027a, 0x02840286, 0x01f4008e
  .long 0x01220120, 0x01260124, 0x01320130, 0x01360134
  .long 0x0288028a, 0x028c028e, 0x0298029a, 0x029c029e
  .long 0x01620160, 0x02e002e2, 0x016a0168, 0x02e802ea
  .long 0x038c038c, 0x038c038c, 0x038c038c, 0x038c038c
  .long 0x03900390, 0x03900390, 0x03900390, 0x03900390
  .long 0x03940394, 0x03940394, 0x03940394, 0x03940394
  .long 0x03980398, 0x03980398, 0x03980398, 0x03980398
  .long 0x039c039c, 0x039c039c, 0x039c039c, 0x039c039c
  .long 0x03200320, 0x03200320, 0x03200320, 0x03200320
  .long 0x03240324, 0x03240324, 0x03240324, 0x03240324
  .long 0x03280328, 0x03280328, 0x03280328, 0x03280328
  .long 0x032c032c, 0x032c032c, 0x032c032c, 0x032c032c
  .long 0x0330013c, 0x03300330, 0x03300330, 0x03300330
  .long 0x02d4013e, 0x03340334, 0x03340334, 0x03340334
  .long 0x019a0030, 0x03380156, 0x03380338, 0x03380338
  .long 0x01980032, 0x02bc02be, 0x033c033c, 0x033c033c
  .long 0x019e0034, 0x01b20048, 0x03400340, 0x03400340
  .long 0x019c0036, 0x01b0004a, 0x03440344, 0x03440344
  .long 0x01a20038, 0x01b6004c, 0x03480348, 0x03480348
  .long 0x01a0003a, 0x01b4004e, 0x034c034c, 0x034c034c
  .long 0x01a6003c, 0x01ba0050, 0x03500144, 0x03500350
  .long 0x01a4003e, 0x01b80052, 0x02d80146, 0x03540354
  .long 0x01aa0040, 0x01be0054, 0x01fa0090, 0x0358015a
  .long 0x01a80042, 0x01bc0056, 0x01f80092, 0x02c402c6
  .long 0x01ae0044, 0x01c20058, 0x01fe0094, 0x021200a8
  .long 0x01ac0046, 0x01c0005a, 0x01fc0096, 0x021000aa
  .long 0x00ee00ec, 0x01c6005c, 0x02020098, 0x021600ac
  .long 0x02540256, 0x01c4005e, 0x0200009a, 0x021400ae
  .long 0x01020100, 0x01060104, 0x0206009c, 0x021a00b0
  .long 0x0268026a, 0x026c026e, 0x0204009e, 0x021800b2
  .long 0x01160114, 0x011a0118, 0x020a00a0, 0x021e00b4
  .long 0x027c027e, 0x02800282, 0x020800a2, 0x021c00b6
  .long 0x012a0128, 0x012e012c, 0x020e00a4, 0x022200b8
  .long 0x02900292, 0x02940296, 0x020c00a6, 0x022000ba
  .long 0x01660164, 0x02e402e6, 0x016e016c, 0x02ec02ee
  .long 0x038c038c, 0x038c038c, 0x038c038c, 0x038c038c
  .long 0x03900390, 0x03900390, 0x03900390, 0x03900390
  .long 0x03940394, 0x03940394, 0x03940394, 0x03940394
  .long 0x03980398, 0x03980398, 0x03980398, 0x03980398
  .long 0x039c039c, 0x039c039c, 0x039c039c, 0x039c039c
  .long 0x03200320, 0x03200320, 0x03200320, 0x0320017c
  .long 0x03240324, 0x03240324, 0x03240324, 0x03240324
  .long 0x03280328, 0x03280328, 0x03280328, 0x03280328
  .long 0x032c032c, 0x032c032c, 0x032c032c, 0x032c032c
  .long 0x03300330, 0x03300330, 0x03300330, 0x03300330
  .long 0x03340334, 0x03340334, 0x03340334, 0x03340334
  .long 0x03380338, 0x03380338, 0x03380338, 0x03380338
  .long 0x033c033c, 0x033c033c, 0x033c033c, 0x033c033c
  .long 0x03400340, 0x03400340, 0x03400340, 0x03400340
  .long 0x03440344, 0x03440344, 0x03440344, 0x03440344
  .long 0x03480348, 0x03480348, 0x03480348, 0x03480348
  .long 0x034c034c, 0x034c034c, 0x034c034c, 0x034c034c
  .long 0x03500350, 0x03500350, 0x03500350, 0x03500350
  .long 0x03540354, 0x03540354, 0x03540354, 0x03540354
  .long 0x03580358, 0x03580358, 0x03580358, 0x03580358
  .long 0x035c035c, 0x035c035c, 0x035c035c, 0x035c035c
  .long 0x03600148, 0x03600360, 0x03600360, 0x03600360
  .long 0x02da014a, 0x03640364, 0x03640364, 0x03640364
  .long 0x022a00c0, 0x0368015c, 0x03680368, 0x03680368
  .long 0x022800c2, 0x02c802ca, 0x036c036c, 0x036c036c
  .long 0x022e00c4, 0x024200d8, 0x03700370, 0x03700370
  .long 0x022c00c6, 0x024000da, 0x03740374, 0x03740374
  .long 0x023200c8, 0x024600dc, 0x03780378, 0x03780378
  .long 0x023000ca, 0x024400de, 0x037c037c, 0x037c037c
  .long 0x023600cc, 0x024a00e0, 0x03800150, 0x03800380
  .long 0x023400ce, 0x024800e2, 0x02de0152, 0x03840384
  .long 0x01720170, 0x02f002f2, 0x017a0178, 0x03880388
  .long 0x038c038c, 0x038c038c, 0x038c038c, 0x038c038c
  .long 0x03900390, 0x03900390, 0x03900390, 0x03900390
  .long 0x03940394, 0x03940394, 0x03940394, 0x03940394
  .long 0x03980398, 0x03980398, 0x03980398, 0x03980398
  .long 0x039c039c, 0x039c039c, 0x039c039c, 0x039c039c
  .long 0x03200320, 0x03200320, 0x03200320, 0x03200320
  .long 0x03240324, 0x03240324, 0x03240324, 0x03240324
  .long 0x03280328, 0x03280328, 0x03280328, 0x03280328
  .long 0x032c032c, 0x032c032c, 0x032c032c, 0x032c032c
  .long 0x03300330, 0x03300330, 0x03300330, 0x03300330
  .long 0x03340334, 0x03340334, 0x03340334, 0x03340334
  .long 0x03380338, 0x03380338, 0x03380338, 0x03380338
  .long 0x033c033c, 0x033c033c, 0x033c033c, 0x033c033c
  .long 0x03400340, 0x03400340, 0x03400340, 0x03400340
  .long 0x03440344, 0x03440344, 0x03440344, 0x03440344
  .long 0x03480348, 0x03480348, 0x03480348, 0x03480348
  .long 0x034c034c, 0x034c034c, 0x034c034c, 0x034c034c
  .long 0x03500350, 0x03500350, 0x03500350, 0x03500350
  .long 0x03540354, 0x03540354, 0x03540354, 0x03540354
  .long 0x03580358, 0x03580358, 0x03580358, 0x03580358
  .long 0x035c035c, 0x035c035c, 0x035c035c, 0x035c035c
  .long 0x03600360, 0x03600360, 0x03600360, 0x03600360
  .long 0x03640364, 0x03640364, 0x03640364, 0x03640364
  .long 0x03680368, 0x03680368, 0x03680368, 0x03680368
  .long 0x036c036c, 0x036c036c, 0x036c036c, 0x036c036c
  .long 0x0370014c, 0x03700370, 0x03700370, 0x03700370
  .long 0x02dc014e, 0x03740374, 0x03740374, 0x03740374
  .long 0x025a00f0, 0x0378015e, 0x03780378, 0x03780378
  .long 0x025800f2, 0x02cc02ce, 0x037c037c, 0x037c037c
  .long 0x025e00f4, 0x02720108, 0x03800380, 0x03800380
  .long 0x025c00f6, 0x0270010a, 0x03840384, 0x03840384
  .long 0x01760174, 0x02f402f6, 0x03880388, 0x03880388
  .long 0x038c038c, 0x038c038c, 0x038c038c, 0x038c038c
  .long 0x03900390, 0x03900390, 0x03900390, 0x03900390
  .long 0x03940394, 0x03940394, 0x03940394, 0x03940394
  .long 0x03980398, 0x03980398, 0x03980398, 0x03980398
  .long 0x039c039c, 0x039c039c, 0x039c039c, 0x039c039c
  .long 0x3c003c00, 0x3c003c00, 0x3c003c00, 0x3c003c00
  .long 0x3c003c00, 0x3c003c00, 0x3c003c00, 0x3c003c00
  .long 0x3c003c00, 0x3c003c00, 0x3c003c00, 0x3c003c00
  .long 0x3c003c00, 0x3c003c00, 0x3c003c00, 0x3c003c00
  .long 0x3c003c00, 0x3c003c00, 0x3c003c00, 0x3c003c00
  .long 0x3c003c00, 0x3c003c00, 0x3c003c00, 0x3c003c00
  .long 0x3c003c00, 0x3c003c00, 0x3c003c00, 0x3c003c00
  .long 0x3c003c00, 0x3c003c00, 0x3c003c00, 0x3c003c00
  .long 0x3c003c00, 0x3c003c00, 0x3c003c00, 0x3c003c00
  .long 0x3c003c00, 0x3c003c00, 0x3c003c00, 0x3c003c00
  .long 0x3c003c00, 0x3c003c00, 0x3c003c00, 0x3c003c00
  .long 0x3c003c00, 0x3c003c00, 0x3c003c00, 0x3c003c00
  .long 0x3c003c00, 0x3c003c00, 0x3c003c00, 0x3c003c00
  .long 0x3c003c00, 0x3c003c00, 0x3c003c00, 0x3c003c00
  .long 0x3c003c00, 0x3c003c00, 0x3c003c00, 0x3c003c00
  .long 0x3c003c00, 0x3c003c00, 0x3c003c00, 0x3c003c00
  .long 0x3c003c00, 0x3c003c00, 0x3c003c00, 0x3c003c00
  .long 0x3c003c00, 0x3c003c00, 0x3c003c00, 0x3c003c00
  .long 0x3c003c00, 0x3c003c00, 0x3c003c00, 0x3c003c00
  .long 0x3c003c00, 0x3c003c00, 0x3c003800, 0x3c003800
  .long 0x3c003800, 0x3c003800, 0x3c003800, 0x3c003800
  .long 0x3c003800, 0x38003800, 0x38003800, 0x38003800
  .long 0x3c003c00, 0x3c003c00, 0x3c003c00, 0x3c003c00
  .long 0x3c003c00, 0x3c003c00, 0x3c003c00, 0x3c003c00
  .long 0x3c003c00, 0x3c003c00, 0x3c003c00, 0x3c003c00
  .long 0x3c003c00, 0x3c003c00, 0x3c003c00, 0x3c003c00
  .long 0x3c003c00, 0x3c003c00, 0x3c003c00, 0x3c003c00
  .long 0x3c003c00, 0x3c003c00, 0x3c003c00, 0x3c003c00
  .long 0x3c003c00, 0x3c003c00, 0x3c003c00, 0x3c003c00
  .long 0x3c003c00, 0x3c003c00, 0x3c003c00, 0x3c003c00
  .long 0x3c003c00, 0x3c003c00, 0x3c003c00, 0x3c003c00
  .long 0x3c003c00, 0x3c003c00, 0x3c003c00, 0x3c003c00
  .long 0x3c003c00, 0x3c003c00, 0x3c003c00, 0x3c003c00
  .long 0x3c003c00, 0x3c003c00, 0x3c003c00, 0x3c003c00
  .long 0x3c003c00, 0x3c003c00, 0x3c003c00, 0x3c003c00
  .long 0x3c003c00, 0x3c003c00, 0x3c003c00, 0x3c003c00
  .long 0x3c003c00, 0x3c003c00, 0x3c003c00, 0x3c003c00
  .long 0x3c003c00, 0x3c003c00, 0x3c003c00, 0x3c003c00
  .long 0x3c003c00, 0x3c003c00, 0x3c003c00, 0x3c003c00
  .long 0x3c003c00, 0x3c003c00, 0x3c003c00, 0x3c003c00
  .long 0x3c003c00, 0x3c003c00, 0x3c003c00, 0x3c003c00
  .long 0x3c003c00, 0x3c003c00, 0x3c003c00, 0x3c003c00
  .long 0x3c003c00, 0x3c003c00, 0x3c003c00, 0x3c003c00
  .long 0x3c003c00, 0x3c003c00, 0x3c003800, 0x3c003800
  .long 0x3c003800, 0x3c003800, 0x3c003800, 0x3c003800
  .long 0x3c003800, 0x38003800, 0x38003800, 0x38003800
  .long 0x3c003c00, 0x3c003c00, 0x3c003c00, 0x3c003c00
  .long 0x3c003c00, 0x3c003c00, 0x3c003c00, 0x3c003c00
  .long 0x3c003c00, 0x3c003c00, 0x3c003c00, 0x3c003c00
  .long 0x3c003c00, 0x3c003c00, 0x3c003c00, 0x3c003c00
  .long 0x3c003c00, 0x3c003c00, 0x3c003c00, 0x3c003c00
  .long 0x3c003c00, 0x3c003c00, 0x3c003c00, 0x3c003c00
  .long 0x3c003c00, 0x3c003c00, 0x3c003c00, 0x3c003c00
  .long 0x3c003c00, 0x3c003c00, 0x3c003c00, 0x3c003c00
  .long 0x3c003c00, 0x3c003c00, 0x3c003c00, 0x3c003c00
  .long 0x3c003c00, 0x3c003c00, 0x3c003c00, 0x3c003c00
  .long 0x3c003c00, 0x3c003c00, 0x3c003c00, 0x3c003c00
  .long 0x3c003c00, 0x3c003c00, 0x3c003c00, 0x3c003c00
  .long 0x3c003c00, 0x3c003c00, 0x3c003c00, 0x3c003c00
  .long 0x3c003c00, 0x3c003c00, 0x3c003c00, 0x3c003c00
  .long 0x3c003c00, 0x3c003c00, 0x3c003c00, 0x3c003c00
  .long 0x3c003c00, 0x3c003c00, 0x3c003c00, 0x3c003c00
  .long 0x3c003c00, 0x3c003c00, 0x3c003c00, 0x3c003c00
  .long 0x3c003c00, 0x3c003c00, 0x3c003c00, 0x3c003c00
.size L_lut, 3072
L_lut_end:
.section .rodata,"a"
.p2align 6
.amdhsa_kernel standalone__deep_cross_xdeepfm__recsys_kernel
  .amdhsa_next_free_vgpr 256
  .amdhsa_next_free_sgpr 102
  .amdhsa_accum_offset 256
  .amdhsa_group_segment_fixed_size 0
  .amdhsa_kernarg_size 88
  .amdhsa_user_sgpr_count 2
  .amdhsa_user_sgpr_kernarg_segment_ptr 1
  .amdhsa_system_sgpr_workgroup_id_x 1
.end_amdhsa_kernel
```
